```python
import torch

def _softmax(x, axis=-1):
    return torch.softmax(x, dim=axis)
def _gelu(x):
    return torch.nn.functional.gelu(x, approximate="tanh")
def _silu(x):
    return torch.nn.functional.silu(x)
def _sigmoid(x):
    return torch.sigmoid(x)
def _layernorm(x, axis=-1, eps=1e-5):
    m = x.mean(dim=axis, keepdim=True)
    v = x.var(dim=axis, keepdim=True, unbiased=False)
    return (x - m) / torch.sqrt(v + eps)
def _scatter_add(tgt, idx, src, axis=0):
    return tgt.clone().index_add_(axis, idx, src)
def _segment_sum(src, seg, n):
    out = torch.zeros((n,) + src.shape[1:], dtype=src.dtype)
    return out.index_add_(0, seg, src)
def _pad(x, pw):
    flat = tuple(v for pair in reversed(pw) for v in pair)
    return torch.nn.functional.pad(x, flat)

kernel_name = 'gated_mix__sliding_block_cached__sliding_block_cached__decode'

def setup_inputs():

    _w = (lambda a: (lambda t: t.to(torch.bfloat16) if t.is_floating_point() else t)(torch.as_tensor(a)))
    def _A_setup():
        B, Sq, D = 8, 1, 448
        Hq, Hkv, Sk, Dh = 16, 8, 4096, 256
        assert Hq % Hkv == 0, (Hq, Hkv)
        return {
            "x": _w((lambda *s: torch.randn(*s, dtype=torch.bfloat16) * 0.05)(B, Sq, D)),
            "k_cache": _w((lambda *s: torch.randn(*s, dtype=torch.bfloat16) * 3.2)(B, Hkv, Sk, Dh)),
            "v_cache": _w((lambda *s: torch.randn(*s, dtype=torch.bfloat16) * 0.05)(B, Hkv, Sk, Dh)),
            "wq": _w((lambda *s: torch.randn(*s, dtype=torch.bfloat16) * 3.2)(D, Hq * Dh) * (D ** -0.5)),
            "wo": _w((lambda *s: torch.randn(*s, dtype=torch.bfloat16) * 0.05)(Hq * Dh, D) * ((Hq * Dh) ** -0.5)),
        }
    _A_in = _A_setup()

    def _B_setup():
        B, Sq, D = 8, 1, 448
        Hq, Hkv, Sk, Dh = 16, 8, 4096, 256
        assert Hq % Hkv == 0, (Hq, Hkv)
        return {
            "x": _w((lambda *s: torch.randn(*s, dtype=torch.bfloat16) * 0.05)(B, Sq, D)),
            "k_cache": _w((lambda *s: torch.randn(*s, dtype=torch.bfloat16) * 3.2)(B, Hkv, Sk, Dh)),
            "v_cache": _w((lambda *s: torch.randn(*s, dtype=torch.bfloat16) * 0.05)(B, Hkv, Sk, Dh)),
            "wq": _w((lambda *s: torch.randn(*s, dtype=torch.bfloat16) * 3.2)(D, Hq * Dh) * (D ** -0.5)),
            "wo": _w((lambda *s: torch.randn(*s, dtype=torch.bfloat16) * 0.05)(Hq * Dh, D) * ((Hq * Dh) ** -0.5)),
        }
    _B_in = _B_setup()

    return {
        "A_x": _A_in["x"],
        "A_k_cache": _A_in["k_cache"],
        "A_v_cache": _A_in["v_cache"],
        "A_wq": _A_in["wq"],
        "A_wo": _A_in["wo"],
        "B_x": _B_in["x"],
        "B_k_cache": _B_in["k_cache"],
        "B_v_cache": _B_in["v_cache"],
        "B_wq": _B_in["wq"],
        "B_wo": _B_in["wo"],
        "gate_w": _w((lambda *s: torch.randn(*s, dtype=torch.bfloat16) * 0.05)(448) * 16.0),
    }

def reference(A_x, A_k_cache, A_v_cache, A_wq, A_wo, B_x, B_k_cache, B_v_cache, B_wq, B_wo, gate_w):
    def _A_ref(x, k_cache, v_cache, wq, wo):
        B, Sq, D = x.shape
        Hq, Dh = 16, 256
        Hkv, Sk = k_cache.shape[1], k_cache.shape[2]
        W = min(4096, max(256, Sk // 4))
        rep = Hq // Hkv
        q = (lambda x, *d: x.permute(*d))((x @ wq).reshape(B, Sq, Hq, Dh), 0, 2, 1, 3)
        k = (lambda x, n, axis: torch.repeat_interleave(x, n, dim=axis))(k_cache[:, :, Sk - W:, :], rep, axis=1)
        v = (lambda x, n, axis: torch.repeat_interleave(x, n, dim=axis))(v_cache[:, :, Sk - W:, :], rep, axis=1)
        scores = torch.einsum("bhqd,bhkd->bhqk", q, k) * (Dh ** -0.5)
        p = _softmax(scores, axis=-1)
        o = torch.einsum("bhqk,bhkd->bhqd", p, v)
        return (lambda x, *d: x.permute(*d))(o, 0, 2, 1, 3).reshape(B, Sq, Hq * Dh) @ wo

    def _B_ref(x, k_cache, v_cache, wq, wo):
        B, Sq, D = x.shape
        Hq, Dh = 16, 256
        Hkv, Sk = k_cache.shape[1], k_cache.shape[2]
        W = min(4096, max(256, Sk // 4))
        rep = Hq // Hkv
        q = (lambda x, *d: x.permute(*d))((x @ wq).reshape(B, Sq, Hq, Dh), 0, 2, 1, 3)
        k = (lambda x, n, axis: torch.repeat_interleave(x, n, dim=axis))(k_cache[:, :, Sk - W:, :], rep, axis=1)
        v = (lambda x, n, axis: torch.repeat_interleave(x, n, dim=axis))(v_cache[:, :, Sk - W:, :], rep, axis=1)
        scores = torch.einsum("bhqd,bhkd->bhqk", q, k) * (Dh ** -0.5)
        p = _softmax(scores, axis=-1)
        o = torch.einsum("bhqk,bhkd->bhqd", p, v)
        return (lambda x, *d: x.permute(*d))(o, 0, 2, 1, 3).reshape(B, Sq, Hq * Dh) @ wo

    x = A_x
    g = _sigmoid((x * gate_w).sum(-1, keepdims=True))
    a = _A_ref(x, A_k_cache, A_v_cache, A_wq, A_wo)
    b = _B_ref(x, B_k_cache, B_v_cache, B_wq, B_wo)
    return g * a + (1 - g) * b
```

```asm
; @launch grid=(256,1,1) block=(512,1,1) lds=95232
.amdgcn_target "amdgcn-amd-amdhsa--gfx950"
.text
.globl gated_mix__sliding_block_cached__sliding_block_cached__decode_kernel
.p2align 8
.type gated_mix__sliding_block_cached__sliding_block_cached__decode_kernel,@function
gated_mix__sliding_block_cached__sliding_block_cached__decode_kernel:
  s_cmp_ge_u32 s2, 256
  s_cbranch_scc1 L_end
  s_getpc_b64 s[80:81]
L_pc:
  v_lshlrev_b32 v35, 7, v0
  v_min_u32 v35, L_codeend-L_pc-4, v35
  global_load_dword v36, v35, s[80:81]
  s_lshr_b32 s4, s2, 7
  s_mul_i32 s58, s4, 40
  s_add_u32 s60, s0, s58
  s_addc_u32 s61, s1, 0
  s_load_dwordx8 s[8:15], s[60:61], 8
  s_load_dwordx2 s[40:41], s[0:1], 0
  s_load_dwordx2 s[48:49], s[0:1], 104
  s_load_dwordx4 s[20:23], s[0:1], 80
  v_lshrrev_b32 v5, 6, v0
  v_and_b32 v1, 63, v0
  v_readfirstlane_b32 s56, v5
  s_and_b32 s3, s2, 7
  s_bfe_u32 s5, s2, 0x40003
  s_lshr_b32 s6, s5, 1
  s_lshl_b32 s58, s6, 3
  s_or_b32 s58, s58, s3
  s_lshl_b32 s58, s58, 3
  s_and_b32 s59, s5, 1
  s_or_b32 s58, s58, s59
  s_or_b32 s58, s58, 6
  s_lshl_b32 s58, s58, 4
  s_xor_b32 s59, s56, s5
  s_and_b32 s59, s59, 7
  s_or_b32 s58, s58, s59
  s_lshl_b32 s58, s58, 14
  s_and_b32 s57, s5, 8
  s_lshl_b32 s57, s57, 6
  s_and_b32 s59, s56, 1
  s_or_b32 s57, s57, s59
  s_lshl_b32 s57, s57, 8
  v_bfe_u32 v5, v1, 2, 2
  v_lshrrev_b32 v6, 4, v1
  v_lshl_add_u32 v2, v5, 6, v6
  v_and_b32 v5, 3, v1
  v_lshl_add_u32 v2, v2, 2, v5
  v_lshl_add_u32 v2, v2, 4, s58
  s_mov_b32 s26, 0x8000000
  s_mov_b32 s27, 0x20000
  s_mov_b32 s34, 3670016
  s_mov_b32 s35, 0x20000
  s_lshl_b32 s60, s3, 10
  s_cmp_eq_u32 s56, 0
  s_cbranch_scc0 L_notw0
  v_lshrrev_b32 v32, 2, v1
  v_lshl_add_u32 v32, v32, 9, v5
  s_lshl_b32 s59, s5, 6
  s_add_u32 s60, s60, s59
  v_lshlrev_b32 v32, 4, v32
  v_mov_b32 v34, 0
  v_mov_b32 v35, 0
  s_mov_b32 m0, 10240
  ds_write_b64 v34, v[34:35] offset:1216
  ds_write_b32 v34, v34 offset:1224
  s_waitcnt lgkmcnt(0)
  s_mov_b32 s32, s12
  s_mov_b32 s33, s13
  v_lshlrev_b32 v33, 4, v1
  s_mov_b32 s50, 8388608
  s_mov_b32 s51, 0x20000
  s_mov_b32 s42, 7168
  s_mov_b32 s43, 0x20000
  s_mov_b32 m0, 38912
  s_movk_i32 s59, 0x1000
  buffer_load_dwordx4 v33, s[40:43], 0 offen offset:0 lds
  buffer_load_dwordx4 v33, s[40:43], 0 offen offset:1024 lds
  buffer_load_dwordx4 v33, s[40:43], 0 offen offset:2048 lds
  buffer_load_dwordx4 v33, s[40:43], 0 offen offset:3072 lds
  s_mov_b32 m0, 43008
  buffer_load_dword v4, v34, s[48:51], 0 offen sc1
  buffer_load_dwordx4 v33, s[40:43], s59 offen offset:0 lds
  buffer_load_dwordx4 v33, s[40:43], s59 offen offset:1024 lds
  buffer_load_dwordx4 v33, s[40:43], s59 offen offset:2048 lds
  s_mov_b32 m0, 10240
  s_nop 0
L_wql:
  buffer_load_dwordx4 v32, s[32:35], s60 offen nt lds
  s_add_u32 m0, m0, 1024
  s_add_u32 s60, s60, 131072
  s_cmp_lt_u32 m0, 38912
  s_cbranch_scc1 L_wql
  s_barrier
  s_branch L_w0b
L_notw0:
  v_lshlrev_b32 v37, 13, v1
  s_mul_i32 s59, s5, 229376
  s_add_u32 s60, s60, s59
  s_add_u32 s60, s60, 384
  s_cmp_gt_u32 s56, 1
  s_waitcnt lgkmcnt(0)
  s_mov_b32 s24, s8
  s_mov_b32 s25, s9
  s_cbranch_scc1 L_novpf
  s_mov_b32 s32, s12
  s_mov_b32 s33, s13
  s_mov_b64 exec, 0xfffffff
  buffer_load_dword v38, v37, s[32:35], s60 offen nt
  s_mov_b64 exec, -1
L_novpf:
  s_xor_b32 s47, s57, 0
  buffer_load_dwordx4 v[128:131], v2, s[24:27], s47 offen nt
  s_xor_b32 s47, s57, 256
  buffer_load_dwordx4 v[132:135], v2, s[24:27], s47 offen nt
  s_barrier
  s_xor_b32 s47, s57, 512
  buffer_load_dwordx4 v[136:139], v2, s[24:27], s47 offen nt
  s_xor_b32 s47, s57, 768
  buffer_load_dwordx4 v[140:143], v2, s[24:27], s47 offen nt
  s_xor_b32 s47, s57, 1024
  buffer_load_dwordx4 v[144:147], v2, s[24:27], s47 offen nt
  s_xor_b32 s47, s57, 1280
  buffer_load_dwordx4 v[148:151], v2, s[24:27], s47 offen nt
  s_xor_b32 s47, s57, 1536
  buffer_load_dwordx4 v[152:155], v2, s[24:27], s47 offen nt
  s_xor_b32 s47, s57, 1792
  buffer_load_dwordx4 v[156:159], v2, s[24:27], s47 offen nt
  s_xor_b32 s47, s57, 2048
  buffer_load_dwordx4 v[160:163], v2, s[24:27], s47 offen nt
  s_xor_b32 s47, s57, 2304
  buffer_load_dwordx4 v[164:167], v2, s[24:27], s47 offen nt
  s_xor_b32 s47, s57, 2560
  buffer_load_dwordx4 v[168:171], v2, s[24:27], s47 offen nt
  s_xor_b32 s47, s57, 2816
  buffer_load_dwordx4 v[172:175], v2, s[24:27], s47 offen nt
  s_xor_b32 s47, s57, 3072
  buffer_load_dwordx4 v[176:179], v2, s[24:27], s47 offen nt
  s_xor_b32 s47, s57, 3328
  buffer_load_dwordx4 v[180:183], v2, s[24:27], s47 offen nt
  s_xor_b32 s47, s57, 3584
  buffer_load_dwordx4 v[184:187], v2, s[24:27], s47 offen nt
  s_xor_b32 s47, s57, 3840
  buffer_load_dwordx4 v[188:191], v2, s[24:27], s47 offen nt
  s_xor_b32 s47, s57, 131072
  buffer_load_dwordx4 v[192:195], v2, s[24:27], s47 offen nt
  s_xor_b32 s47, s57, 131328
  buffer_load_dwordx4 v[196:199], v2, s[24:27], s47 offen nt
  s_xor_b32 s47, s57, 131584
  buffer_load_dwordx4 v[200:203], v2, s[24:27], s47 offen nt
  s_xor_b32 s47, s57, 131840
  buffer_load_dwordx4 v[204:207], v2, s[24:27], s47 offen nt
  s_xor_b32 s47, s57, 132096
  buffer_load_dwordx4 v[208:211], v2, s[24:27], s47 offen nt
  s_xor_b32 s47, s57, 132352
  buffer_load_dwordx4 v[212:215], v2, s[24:27], s47 offen nt
  s_xor_b32 s47, s57, 132608
  buffer_load_dwordx4 v[216:219], v2, s[24:27], s47 offen nt
  s_xor_b32 s47, s57, 132864
  buffer_load_dwordx4 v[220:223], v2, s[24:27], s47 offen nt
  s_xor_b32 s47, s57, 133120
  buffer_load_dwordx4 v[224:227], v2, s[24:27], s47 offen nt
  s_xor_b32 s47, s57, 133376
  buffer_load_dwordx4 v[228:231], v2, s[24:27], s47 offen nt
  s_xor_b32 s47, s57, 133632
  buffer_load_dwordx4 v[232:235], v2, s[24:27], s47 offen nt
  s_xor_b32 s47, s57, 133888
  buffer_load_dwordx4 v[236:239], v2, s[24:27], s47 offen nt
  s_xor_b32 s47, s57, 134144
  buffer_load_dwordx4 v[240:243], v2, s[24:27], s47 offen nt
  s_xor_b32 s47, s57, 134400
  buffer_load_dwordx4 v[244:247], v2, s[24:27], s47 offen nt
  s_xor_b32 s47, s57, 134656
  buffer_load_dwordx4 v[248:251], v2, s[24:27], s47 offen nt
  s_xor_b32 s47, s57, 134912
  buffer_load_dwordx4 v[252:255], v2, s[24:27], s47 offen nt
L_kq0:
  s_lshl_b32 s7, s4, 3
  s_add_u32 s7, s7, s3
  v_lshlrev_b32 v33, 4, v1
  s_mov_b32 s50, 8388608
  s_mov_b32 s51, 0x20000
  s_mov_b32 s42, 7168
  s_mov_b32 s43, 0x20000
  v_readfirstlane_b32 s58, v2
  v_and_b32 v7, 15, v1
  v_lshl_add_u32 v3, v6, 8, v7
  s_cmp_lg_u32 s56, 7
  v_lshl_add_u32 v3, v3, 4, s58
  s_cbranch_scc1 L_nog7
  s_mov_b32 s44, s20
  s_mov_b32 s45, s21
  s_mov_b32 s46, 896
  s_mov_b32 s47, 0x20000
  s_mul_i32 s58, s3, 896
  buffer_load_dwordx4 v[16:19], v33, s[40:43], s58 offen
  buffer_load_dwordx4 v[20:23], v33, s[44:47], 0 offen
L_nog7:
  s_mov_b32 s28, s10
  s_mov_b32 s29, s11
  s_mov_b32 s30, 134217728
  s_mov_b32 s31, 0x20000
  s_mov_b32 s36, s14
  s_mov_b32 s37, s15
  s_mov_b32 s38, 3670016
  s_mov_b32 s39, 0x20000
  s_mov_b32 s52, s22
  s_mov_b32 s53, s23
  s_mov_b32 s54, 7168
  s_mov_b32 s55, 0x20000
  s_mov_b32 s32, s5
  s_cmp_gt_u32 s5, 7
  s_cselect_b32 s58, 2, 0
  s_sub_u32 s32, s32, s58
  s_sub_u32 s58, s5, 6
  s_cmp_lt_u32 s58, 2
  s_cselect_b32 s32, 14, s32
  s_cmp_ge_u32 s32, 7
  s_cselect_b32 s33, 1, 0
  s_mul_i32 s58, s33, 7
  s_sub_u32 s34, s32, s58
  s_mov_b32 s64, 0x00110011
  s_mov_b32 s65, 0x00110011
  s_mov_b32 s66, 0x00220022
  s_mov_b32 s67, 0x00220022
  s_mov_b32 s68, 0x00440044
  s_mov_b32 s69, 0x00440044
  s_mov_b32 s70, 0x00880088
  s_mov_b32 s71, 0x00880088
  s_mov_b32 s72, 0x11001100
  s_mov_b32 s73, 0x11001100
  s_mov_b32 s74, 0x22002200
  s_mov_b32 s75, 0x22002200
  s_mov_b32 s76, 0x44004400
  s_mov_b32 s77, 0x44004400
  s_mov_b32 s78, 0x88008800
  s_mov_b32 s79, 0x88008800
  s_mov_b32 s82, 0x05040100
  s_mov_b32 s83, 0x07060302
  s_mov_b32 s63, 0x3db8aa3b
  s_mov_b32 s80, 0xff00ff00
  s_mov_b32 s81, 0xff00ff00
  s_cmp_lg_u32 s56, 7
  s_cbranch_scc1 L_b2
  s_waitcnt vmcnt(0)
  v_cmp_gt_u32 vcc, 56, v1
  v_mov_b32 v24, 0
  s_nop 0
  v_cndmask_b32 v16, 0, v16, vcc
  v_cndmask_b32 v17, 0, v17, vcc
  v_cndmask_b32 v18, 0, v18, vcc
  v_cndmask_b32 v19, 0, v19, vcc
  v_lshlrev_b32 v25, 16, v16
  v_and_b32 v26, 0xffff0000, v16
  v_lshlrev_b32 v27, 16, v20
  v_and_b32 v28, 0xffff0000, v20
  v_mul_f32 v25, v25, v27
  v_mul_f32 v26, v26, v28
  v_cvt_pk_bf16_f32 v25, v25, v26
  v_lshlrev_b32 v26, 16, v25
  v_and_b32 v25, 0xffff0000, v25
  v_add_f32 v24, v24, v26
  v_add_f32 v24, v24, v25
  v_lshlrev_b32 v25, 16, v17
  v_and_b32 v26, 0xffff0000, v17
  v_lshlrev_b32 v27, 16, v21
  v_and_b32 v28, 0xffff0000, v21
  v_mul_f32 v25, v25, v27
  v_mul_f32 v26, v26, v28
  v_cvt_pk_bf16_f32 v25, v25, v26
  v_lshlrev_b32 v26, 16, v25
  v_and_b32 v25, 0xffff0000, v25
  v_add_f32 v24, v24, v26
  v_add_f32 v24, v24, v25
  v_lshlrev_b32 v25, 16, v18
  v_and_b32 v26, 0xffff0000, v18
  v_lshlrev_b32 v27, 16, v22
  v_and_b32 v28, 0xffff0000, v22
  v_mul_f32 v25, v25, v27
  v_mul_f32 v26, v26, v28
  v_cvt_pk_bf16_f32 v25, v25, v26
  v_lshlrev_b32 v26, 16, v25
  v_and_b32 v25, 0xffff0000, v25
  v_add_f32 v24, v24, v26
  v_add_f32 v24, v24, v25
  v_lshlrev_b32 v25, 16, v19
  v_and_b32 v26, 0xffff0000, v19
  v_lshlrev_b32 v27, 16, v23
  v_and_b32 v28, 0xffff0000, v23
  v_mul_f32 v25, v25, v27
  v_mul_f32 v26, v26, v28
  v_cvt_pk_bf16_f32 v25, v25, v26
  v_lshlrev_b32 v26, 16, v25
  v_and_b32 v25, 0xffff0000, v25
  v_add_f32 v24, v24, v26
  v_add_f32 v24, v24, v25
  s_nop 1
  v_add_f32_dpp v24, v24, v24 quad_perm:[1,0,3,2] row_mask:0xf bank_mask:0xf
  s_nop 1
  v_add_f32_dpp v24, v24, v24 quad_perm:[2,3,0,1] row_mask:0xf bank_mask:0xf
  s_nop 1
  v_add_f32_dpp v24, v24, v24 row_ror:4 row_mask:0xf bank_mask:0xf
  s_nop 1
  v_add_f32_dpp v24, v24, v24 row_ror:8 row_mask:0xf bank_mask:0xf
  v_mov_b32 v25, v24
  s_nop 1
  v_permlane16_swap_b32 v24, v25
  v_add_f32 v24, v24, v25
  v_mov_b32 v25, v24
  s_nop 1
  v_permlane32_swap_b32 v24, v25
  v_add_f32 v24, v24, v25
  v_cvt_pk_bf16_f32 v24, v24, v24
  v_and_b32 v24, 0xffff0000, v24
  v_mul_f32 v24, 0xbfb8aa3b, v24
  v_exp_f32 v24, v24
  s_nop 0
  v_add_f32 v24, 1.0, v24
  v_rcp_f32 v24, v24
  s_nop 0
  v_cvt_pk_bf16_f32 v24, v24, v24
  v_and_b32 v24, 0xffff0000, v24
  v_sub_f32 v25, 1.0, v24
  v_cvt_pk_bf16_f32 v25, v25, v25
  v_and_b32 v25, 0xffff0000, v25
  v_readfirstlane_b32 s22, v24
  v_readfirstlane_b32 s23, v25
L_b2:
  v_bfe_u32 v7, v1, 2, 1
  v_lshlrev_b32 v5, 9, v7
  v_lshl_add_u32 v5, v6, 6, v5
  v_and_b32 v60, 3, v1
  v_lshl_add_u32 v5, v60, 4, v5
  s_and_b32 s58, s57, 0x100
  v_add_u32 v5, s58, v5
  v_xor_b32 v60, 0x100, v5
  v_mov_b32 v62, 0
  s_mov_b32 s42, 1
  s_mov_b32 s62, 0x400000
L_qwait:
  ds_read_b32 v61, v62 offset:1216
  s_waitcnt lgkmcnt(0)
  v_readfirstlane_b32 s42, v61
  s_cmp_lg_u32 s42, 0
  s_cbranch_scc1 L_qready
  s_sleep 2
  s_sub_u32 s62, s62, 1
  s_cbranch_scc0 L_qwait
L_qready:
  v_and_b32 v4, -8, v61
  s_and_b32 s42, s42, 7
  ds_read_b128 v[8:11], v5 offset:0
  ds_read_b128 v[12:15], v60 offset:0
  s_waitcnt lgkmcnt(0)
  s_waitcnt vmcnt(24)
  v_mfma_f32_16x16x32_bf16 v[32:35], v[128:131], v[8:11], 0
  v_mfma_f32_16x16x32_bf16 v[32:35], v[132:135], v[12:15], v[32:35]
  v_mfma_f32_16x16x32_bf16 v[36:39], v[136:139], v[8:11], 0
  v_mfma_f32_16x16x32_bf16 v[36:39], v[140:143], v[12:15], v[36:39]
  v_mfma_f32_16x16x32_bf16 v[40:43], v[144:147], v[8:11], 0
  v_mfma_f32_16x16x32_bf16 v[40:43], v[148:151], v[12:15], v[40:43]
  v_mfma_f32_16x16x32_bf16 v[44:47], v[152:155], v[8:11], 0
  v_mfma_f32_16x16x32_bf16 v[44:47], v[156:159], v[12:15], v[44:47]
  s_xor_b32 s47, s57, 0
  buffer_load_dwordx4 v[128:131], v3, s[28:31], s47 offen nt
  s_xor_b32 s47, s57, 512
  buffer_load_dwordx4 v[132:135], v3, s[28:31], s47 offen nt
  s_xor_b32 s47, s57, 1024
  buffer_load_dwordx4 v[136:139], v3, s[28:31], s47 offen nt
  s_xor_b32 s47, s57, 1536
  buffer_load_dwordx4 v[140:143], v3, s[28:31], s47 offen nt
  s_xor_b32 s47, s57, 2048
  buffer_load_dwordx4 v[144:147], v3, s[28:31], s47 offen nt
  s_xor_b32 s47, s57, 2560
  buffer_load_dwordx4 v[148:151], v3, s[28:31], s47 offen nt
  s_xor_b32 s47, s57, 3072
  buffer_load_dwordx4 v[152:155], v3, s[28:31], s47 offen nt
  s_xor_b32 s47, s57, 3584
  buffer_load_dwordx4 v[156:159], v3, s[28:31], s47 offen nt
  s_waitcnt vmcnt(24)
  v_mfma_f32_16x16x32_bf16 v[48:51], v[160:163], v[8:11], 0
  v_mfma_f32_16x16x32_bf16 v[48:51], v[164:167], v[12:15], v[48:51]
  v_mfma_f32_16x16x32_bf16 v[52:55], v[168:171], v[8:11], 0
  v_mfma_f32_16x16x32_bf16 v[52:55], v[172:175], v[12:15], v[52:55]
  v_mfma_f32_16x16x32_bf16 v[56:59], v[176:179], v[8:11], 0
  v_mfma_f32_16x16x32_bf16 v[56:59], v[180:183], v[12:15], v[56:59]
  v_mfma_f32_16x16x32_bf16 v[60:63], v[184:187], v[8:11], 0
  v_mfma_f32_16x16x32_bf16 v[60:63], v[188:191], v[12:15], v[60:63]
  s_xor_b32 s47, s57, 256
  buffer_load_dwordx4 v[160:163], v3, s[28:31], s47 offen nt
  s_xor_b32 s47, s57, 768
  buffer_load_dwordx4 v[164:167], v3, s[28:31], s47 offen nt
  s_xor_b32 s47, s57, 1280
  buffer_load_dwordx4 v[168:171], v3, s[28:31], s47 offen nt
  s_xor_b32 s47, s57, 1792
  buffer_load_dwordx4 v[172:175], v3, s[28:31], s47 offen nt
  s_xor_b32 s47, s57, 2304
  buffer_load_dwordx4 v[176:179], v3, s[28:31], s47 offen nt
  s_xor_b32 s47, s57, 2816
  buffer_load_dwordx4 v[180:183], v3, s[28:31], s47 offen nt
  s_xor_b32 s47, s57, 3328
  buffer_load_dwordx4 v[184:187], v3, s[28:31], s47 offen nt
  s_xor_b32 s47, s57, 3840
  buffer_load_dwordx4 v[188:191], v3, s[28:31], s47 offen nt
  v_mov_b32_dpp v16, v32 quad_perm:[0,0,0,0] row_mask:0xf bank_mask:0xf
  v_mov_b32_dpp v17, v36 quad_perm:[0,0,0,0] row_mask:0xf bank_mask:0xf
  v_mov_b32_dpp v18, v40 quad_perm:[0,0,0,0] row_mask:0xf bank_mask:0xf
  v_mov_b32_dpp v19, v44 quad_perm:[0,0,0,0] row_mask:0xf bank_mask:0xf
  v_add_f32_dpp v16, v33, v16 quad_perm:[1,1,1,1] row_mask:0xf bank_mask:0xf
  v_add_f32_dpp v17, v37, v17 quad_perm:[1,1,1,1] row_mask:0xf bank_mask:0xf
  v_add_f32_dpp v18, v41, v18 quad_perm:[1,1,1,1] row_mask:0xf bank_mask:0xf
  v_add_f32_dpp v19, v45, v19 quad_perm:[1,1,1,1] row_mask:0xf bank_mask:0xf
  v_add_f32_dpp v16, v34, v16 quad_perm:[2,2,2,2] row_mask:0xf bank_mask:0xf
  v_add_f32_dpp v17, v38, v17 quad_perm:[2,2,2,2] row_mask:0xf bank_mask:0xf
  v_add_f32_dpp v18, v42, v18 quad_perm:[2,2,2,2] row_mask:0xf bank_mask:0xf
  v_add_f32_dpp v19, v46, v19 quad_perm:[2,2,2,2] row_mask:0xf bank_mask:0xf
  v_add_f32_dpp v16, v35, v16 quad_perm:[3,3,3,3] row_mask:0xf bank_mask:0xf
  v_add_f32_dpp v17, v39, v17 quad_perm:[3,3,3,3] row_mask:0xf bank_mask:0xf
  v_add_f32_dpp v18, v43, v18 quad_perm:[3,3,3,3] row_mask:0xf bank_mask:0xf
  v_add_f32_dpp v19, v47, v19 quad_perm:[3,3,3,3] row_mask:0xf bank_mask:0xf
  v_mov_b32_dpp v20, v48 quad_perm:[0,0,0,0] row_mask:0xf bank_mask:0xf
  v_mov_b32_dpp v21, v52 quad_perm:[0,0,0,0] row_mask:0xf bank_mask:0xf
  v_mov_b32_dpp v22, v56 quad_perm:[0,0,0,0] row_mask:0xf bank_mask:0xf
  v_mov_b32_dpp v23, v60 quad_perm:[0,0,0,0] row_mask:0xf bank_mask:0xf
  v_add_f32_dpp v20, v49, v20 quad_perm:[1,1,1,1] row_mask:0xf bank_mask:0xf
  v_add_f32_dpp v21, v53, v21 quad_perm:[1,1,1,1] row_mask:0xf bank_mask:0xf
  v_add_f32_dpp v22, v57, v22 quad_perm:[1,1,1,1] row_mask:0xf bank_mask:0xf
  v_add_f32_dpp v23, v61, v23 quad_perm:[1,1,1,1] row_mask:0xf bank_mask:0xf
  v_add_f32_dpp v20, v50, v20 quad_perm:[2,2,2,2] row_mask:0xf bank_mask:0xf
  v_add_f32_dpp v21, v54, v21 quad_perm:[2,2,2,2] row_mask:0xf bank_mask:0xf
  v_add_f32_dpp v22, v58, v22 quad_perm:[2,2,2,2] row_mask:0xf bank_mask:0xf
  v_add_f32_dpp v23, v62, v23 quad_perm:[2,2,2,2] row_mask:0xf bank_mask:0xf
  v_add_f32_dpp v20, v51, v20 quad_perm:[3,3,3,3] row_mask:0xf bank_mask:0xf
  v_add_f32_dpp v21, v55, v21 quad_perm:[3,3,3,3] row_mask:0xf bank_mask:0xf
  v_add_f32_dpp v22, v59, v22 quad_perm:[3,3,3,3] row_mask:0xf bank_mask:0xf
  v_add_f32_dpp v23, v63, v23 quad_perm:[3,3,3,3] row_mask:0xf bank_mask:0xf
  v_lshlrev_b32 v7, 5, v7
  s_lshl_b32 s58, s56, 2
  v_add_u32 v58, s58, v7
  v_bfe_u32 v7, v1, 4, 1
  v_lshlrev_b32 v56, 10, v7
  v_lshlrev_b32 v7, 5, v7
  v_and_b32 v57, 15, v1
  v_lshl_add_u32 v56, v57, 5, v56
  v_lshrrev_b32 v57, 5, v1
  v_lshl_add_u32 v56, v57, 4, v56
  s_and_b32 s59, s57, 0x100
  s_lshl_b32 s59, s59, 1
  v_add_u32 v56, s59, v56
  v_xor_b32 v57, 0x200, v56
  s_lshl_b32 s58, s56, 11
  s_add_u32 s58, s58, 78848
  v_add_u32 v56, s58, v56
  v_add_u32 v57, s58, v57
  v_cvt_pk_bf16_f32 v120, v16, v17
  v_cvt_pk_bf16_f32 v121, v18, v19
  v_cvt_pk_bf16_f32 v122, v20, v21
  v_cvt_pk_bf16_f32 v123, v22, v23
  v_lshlrev_b32 v16, 16, v120
  v_and_b32 v17, 0xffff0000, v120
  v_lshlrev_b32 v18, 16, v121
  v_and_b32 v19, 0xffff0000, v121
  v_lshlrev_b32 v20, 16, v122
  v_and_b32 v21, 0xffff0000, v122
  v_lshlrev_b32 v22, 16, v123
  v_and_b32 v23, 0xffff0000, v123
  v_max3_f32 v5, v16, v17, v18
  v_max3_f32 v6, v19, v20, v21
  v_max3_f32 v5, v5, v22, v23
  v_max_f32 v5, v5, v6
  v_mov_b32 v6, v5
  s_nop 1
  v_permlane16_swap_b32 v5, v6
  v_max_f32 v5, v5, v6
  v_mov_b32 v6, v5
  s_nop 1
  v_permlane32_swap_b32 v5, v6
  v_max_f32 v5, v5, v6
  v_mul_f32 v52, s63, v5
  v_fma_f32 v16, v16, s63, -v52
  v_fma_f32 v17, v17, s63, -v52
  v_fma_f32 v18, v18, s63, -v52
  v_fma_f32 v19, v19, s63, -v52
  v_fma_f32 v20, v20, s63, -v52
  v_fma_f32 v21, v21, s63, -v52
  v_fma_f32 v22, v22, s63, -v52
  v_fma_f32 v23, v23, s63, -v52
  v_exp_f32 v16, v16
  v_exp_f32 v17, v17
  v_exp_f32 v18, v18
  v_exp_f32 v19, v19
  v_exp_f32 v20, v20
  v_exp_f32 v21, v21
  v_exp_f32 v22, v22
  v_exp_f32 v23, v23
  s_nop 0
  v_cvt_pk_bf16_f32 v120, v16, v17
  v_cvt_pk_bf16_f32 v121, v18, v19
  v_cvt_pk_bf16_f32 v122, v20, v21
  v_cvt_pk_bf16_f32 v123, v22, v23
  v_add_f32 v16, v16, v20
  v_add_f32 v17, v17, v21
  v_add_f32 v18, v18, v22
  v_add_f32 v19, v19, v23
  v_add_f32 v16, v16, v18
  v_add_f32 v17, v17, v19
  v_add_f32 v53, v16, v17
  v_cndmask_b32 v64, 0, v120, s[64:65]
  v_cndmask_b32 v65, 0, v121, s[64:65]
  v_cndmask_b32 v66, 0, v122, s[64:65]
  v_cndmask_b32 v67, 0, v123, s[64:65]
  v_cndmask_b32 v68, 0, v120, s[66:67]
  v_cndmask_b32 v69, 0, v121, s[66:67]
  v_cndmask_b32 v70, 0, v122, s[66:67]
  v_cndmask_b32 v71, 0, v123, s[66:67]
  v_cndmask_b32 v72, 0, v120, s[68:69]
  v_cndmask_b32 v73, 0, v121, s[68:69]
  v_cndmask_b32 v74, 0, v122, s[68:69]
  v_cndmask_b32 v75, 0, v123, s[68:69]
  v_cndmask_b32 v76, 0, v120, s[70:71]
  v_cndmask_b32 v77, 0, v121, s[70:71]
  v_cndmask_b32 v78, 0, v122, s[70:71]
  v_cndmask_b32 v79, 0, v123, s[70:71]
  v_cndmask_b32 v80, 0, v120, s[72:73]
  v_cndmask_b32 v81, 0, v121, s[72:73]
  v_cndmask_b32 v82, 0, v122, s[72:73]
  v_cndmask_b32 v83, 0, v123, s[72:73]
  v_cndmask_b32 v84, 0, v120, s[74:75]
  v_cndmask_b32 v85, 0, v121, s[74:75]
  v_cndmask_b32 v86, 0, v122, s[74:75]
  v_cndmask_b32 v87, 0, v123, s[74:75]
  v_cndmask_b32 v88, 0, v120, s[76:77]
  v_cndmask_b32 v89, 0, v121, s[76:77]
  v_cndmask_b32 v90, 0, v122, s[76:77]
  v_cndmask_b32 v91, 0, v123, s[76:77]
  v_cndmask_b32 v92, 0, v120, s[78:79]
  v_cndmask_b32 v93, 0, v121, s[78:79]
  v_cndmask_b32 v94, 0, v122, s[78:79]
  v_cndmask_b32 v95, 0, v123, s[78:79]
  s_waitcnt vmcnt(24)
  v_mfma_f32_16x16x32_bf16 v[32:35], v[192:195], v[8:11], 0
  v_mfma_f32_16x16x32_bf16 v[32:35], v[196:199], v[12:15], v[32:35]
  v_mfma_f32_16x16x32_bf16 v[36:39], v[200:203], v[8:11], 0
  v_mfma_f32_16x16x32_bf16 v[36:39], v[204:207], v[12:15], v[36:39]
  v_mfma_f32_16x16x32_bf16 v[40:43], v[208:211], v[8:11], 0
  v_mfma_f32_16x16x32_bf16 v[40:43], v[212:215], v[12:15], v[40:43]
  v_mfma_f32_16x16x32_bf16 v[44:47], v[216:219], v[8:11], 0
  v_mfma_f32_16x16x32_bf16 v[44:47], v[220:223], v[12:15], v[44:47]
  s_xor_b32 s47, s57, 131072
  buffer_load_dwordx4 v[192:195], v3, s[28:31], s47 offen nt
  s_xor_b32 s47, s57, 131584
  buffer_load_dwordx4 v[196:199], v3, s[28:31], s47 offen nt
  s_xor_b32 s47, s57, 132096
  buffer_load_dwordx4 v[200:203], v3, s[28:31], s47 offen nt
  s_xor_b32 s47, s57, 132608
  buffer_load_dwordx4 v[204:207], v3, s[28:31], s47 offen nt
  s_xor_b32 s47, s57, 133120
  buffer_load_dwordx4 v[208:211], v3, s[28:31], s47 offen nt
  s_xor_b32 s47, s57, 133632
  buffer_load_dwordx4 v[212:215], v3, s[28:31], s47 offen nt
  s_xor_b32 s47, s57, 134144
  buffer_load_dwordx4 v[216:219], v3, s[28:31], s47 offen nt
  s_xor_b32 s47, s57, 134656
  buffer_load_dwordx4 v[220:223], v3, s[28:31], s47 offen nt
  v_mov_b32_dpp v24, v32 quad_perm:[0,0,0,0] row_mask:0xf bank_mask:0xf
  v_mov_b32_dpp v25, v36 quad_perm:[0,0,0,0] row_mask:0xf bank_mask:0xf
  v_mov_b32_dpp v26, v40 quad_perm:[0,0,0,0] row_mask:0xf bank_mask:0xf
  v_mov_b32_dpp v27, v44 quad_perm:[0,0,0,0] row_mask:0xf bank_mask:0xf
  v_add_f32_dpp v24, v33, v24 quad_perm:[1,1,1,1] row_mask:0xf bank_mask:0xf
  v_add_f32_dpp v25, v37, v25 quad_perm:[1,1,1,1] row_mask:0xf bank_mask:0xf
  v_add_f32_dpp v26, v41, v26 quad_perm:[1,1,1,1] row_mask:0xf bank_mask:0xf
  v_add_f32_dpp v27, v45, v27 quad_perm:[1,1,1,1] row_mask:0xf bank_mask:0xf
  v_add_f32_dpp v24, v34, v24 quad_perm:[2,2,2,2] row_mask:0xf bank_mask:0xf
  v_add_f32_dpp v25, v38, v25 quad_perm:[2,2,2,2] row_mask:0xf bank_mask:0xf
  v_add_f32_dpp v26, v42, v26 quad_perm:[2,2,2,2] row_mask:0xf bank_mask:0xf
  v_add_f32_dpp v27, v46, v27 quad_perm:[2,2,2,2] row_mask:0xf bank_mask:0xf
  v_add_f32_dpp v24, v35, v24 quad_perm:[3,3,3,3] row_mask:0xf bank_mask:0xf
  v_add_f32_dpp v25, v39, v25 quad_perm:[3,3,3,3] row_mask:0xf bank_mask:0xf
  v_add_f32_dpp v26, v43, v26 quad_perm:[3,3,3,3] row_mask:0xf bank_mask:0xf
  v_add_f32_dpp v27, v47, v27 quad_perm:[3,3,3,3] row_mask:0xf bank_mask:0xf
  s_waitcnt vmcnt(16)
  v_perm_b32 v40, v132, v128, s82
  v_perm_b32 v41, v140, v136, s82
  v_perm_b32 v42, v148, v144, s82
  v_perm_b32 v43, v156, v152, s82
  v_perm_b32 v44, v132, v128, s83
  v_perm_b32 v45, v140, v136, s83
  v_perm_b32 v46, v148, v144, s83
  v_perm_b32 v47, v156, v152, s83
  v_mfma_f32_16x16x32_bf16 v[112:115], v[64:67], v[40:43], 0
  v_perm_b32 v48, v133, v129, s82
  v_perm_b32 v49, v141, v137, s82
  v_perm_b32 v50, v149, v145, s82
  v_perm_b32 v51, v157, v153, s82
  v_mfma_f32_16x16x32_bf16 v[112:115], v[68:71], v[44:47], v[112:115]
  v_perm_b32 v40, v133, v129, s83
  v_perm_b32 v41, v141, v137, s83
  v_perm_b32 v42, v149, v145, s83
  v_perm_b32 v43, v157, v153, s83
  v_mfma_f32_16x16x32_bf16 v[112:115], v[72:75], v[48:51], v[112:115]
  v_perm_b32 v44, v134, v130, s82
  v_perm_b32 v45, v142, v138, s82
  v_perm_b32 v46, v150, v146, s82
  v_perm_b32 v47, v158, v154, s82
  v_mfma_f32_16x16x32_bf16 v[112:115], v[76:79], v[40:43], v[112:115]
  v_perm_b32 v48, v134, v130, s83
  v_perm_b32 v49, v142, v138, s83
  v_perm_b32 v50, v150, v146, s83
  v_perm_b32 v51, v158, v154, s83
  v_mfma_f32_16x16x32_bf16 v[112:115], v[80:83], v[44:47], v[112:115]
  v_perm_b32 v40, v135, v131, s82
  v_perm_b32 v41, v143, v139, s82
  v_perm_b32 v42, v151, v147, s82
  v_perm_b32 v43, v159, v155, s82
  v_mfma_f32_16x16x32_bf16 v[112:115], v[84:87], v[48:51], v[112:115]
  v_perm_b32 v44, v135, v131, s83
  v_perm_b32 v45, v143, v139, s83
  v_perm_b32 v46, v151, v147, s83
  v_perm_b32 v47, v159, v155, s83
  v_mfma_f32_16x16x32_bf16 v[112:115], v[88:91], v[40:43], v[112:115]
  s_nop 1
  v_mfma_f32_16x16x32_bf16 v[112:115], v[92:95], v[44:47], v[112:115]
  s_waitcnt vmcnt(24)
  v_mfma_f32_16x16x32_bf16 v[96:99], v[224:227], v[8:11], 0
  v_mfma_f32_16x16x32_bf16 v[96:99], v[228:231], v[12:15], v[96:99]
  v_mfma_f32_16x16x32_bf16 v[100:103], v[232:235], v[8:11], 0
  v_mfma_f32_16x16x32_bf16 v[100:103], v[236:239], v[12:15], v[100:103]
  v_mfma_f32_16x16x32_bf16 v[104:107], v[240:243], v[8:11], 0
  v_mfma_f32_16x16x32_bf16 v[104:107], v[244:247], v[12:15], v[104:107]
  v_mfma_f32_16x16x32_bf16 v[108:111], v[248:251], v[8:11], 0
  v_mfma_f32_16x16x32_bf16 v[108:111], v[252:255], v[12:15], v[108:111]
  s_xor_b32 s47, s57, 131328
  buffer_load_dwordx4 v[224:227], v3, s[28:31], s47 offen nt
  s_xor_b32 s47, s57, 131840
  buffer_load_dwordx4 v[228:231], v3, s[28:31], s47 offen nt
  s_xor_b32 s47, s57, 132352
  buffer_load_dwordx4 v[232:235], v3, s[28:31], s47 offen nt
  s_xor_b32 s47, s57, 132864
  buffer_load_dwordx4 v[236:239], v3, s[28:31], s47 offen nt
  s_xor_b32 s47, s57, 133376
  buffer_load_dwordx4 v[240:243], v3, s[28:31], s47 offen nt
  s_xor_b32 s47, s57, 133888
  buffer_load_dwordx4 v[244:247], v3, s[28:31], s47 offen nt
  s_xor_b32 s47, s57, 134400
  buffer_load_dwordx4 v[248:251], v3, s[28:31], s47 offen nt
  s_xor_b32 s47, s57, 134912
  buffer_load_dwordx4 v[252:255], v3, s[28:31], s47 offen nt
  v_mov_b32 v60, 1
  v_mov_b32 v61, 0
  s_mov_b64 exec, 1
  ds_add_u32 v61, v60 offset:1224
  s_mov_b64 exec, -1
  s_waitcnt vmcnt(16)
  v_perm_b32 v40, v164, v160, s82
  v_perm_b32 v41, v172, v168, s82
  v_perm_b32 v42, v180, v176, s82
  v_perm_b32 v43, v188, v184, s82
  v_perm_b32 v44, v164, v160, s83
  v_perm_b32 v45, v172, v168, s83
  v_perm_b32 v46, v180, v176, s83
  v_perm_b32 v47, v188, v184, s83
  v_mfma_f32_16x16x32_bf16 v[116:119], v[64:67], v[40:43], 0
  v_perm_b32 v48, v165, v161, s82
  v_perm_b32 v49, v173, v169, s82
  v_perm_b32 v50, v181, v177, s82
  v_perm_b32 v51, v189, v185, s82
  v_mfma_f32_16x16x32_bf16 v[116:119], v[68:71], v[44:47], v[116:119]
  v_perm_b32 v40, v165, v161, s83
  v_perm_b32 v41, v173, v169, s83
  v_perm_b32 v42, v181, v177, s83
  v_perm_b32 v43, v189, v185, s83
  v_mfma_f32_16x16x32_bf16 v[116:119], v[72:75], v[48:51], v[116:119]
  v_perm_b32 v44, v166, v162, s82
  v_perm_b32 v45, v174, v170, s82
  v_perm_b32 v46, v182, v178, s82
  v_perm_b32 v47, v190, v186, s82
  v_mfma_f32_16x16x32_bf16 v[116:119], v[76:79], v[40:43], v[116:119]
  v_perm_b32 v48, v166, v162, s83
  v_perm_b32 v49, v174, v170, s83
  v_perm_b32 v50, v182, v178, s83
  v_perm_b32 v51, v190, v186, s83
  v_mfma_f32_16x16x32_bf16 v[116:119], v[80:83], v[44:47], v[116:119]
  v_perm_b32 v40, v167, v163, s82
  v_perm_b32 v41, v175, v171, s82
  v_perm_b32 v42, v183, v179, s82
  v_perm_b32 v43, v191, v187, s82
  v_mfma_f32_16x16x32_bf16 v[116:119], v[84:87], v[48:51], v[116:119]
  v_perm_b32 v44, v167, v163, s83
  v_perm_b32 v45, v175, v171, s83
  v_perm_b32 v46, v183, v179, s83
  v_perm_b32 v47, v191, v187, s83
  v_mfma_f32_16x16x32_bf16 v[116:119], v[88:91], v[40:43], v[116:119]
  s_nop 1
  v_mfma_f32_16x16x32_bf16 v[116:119], v[92:95], v[44:47], v[116:119]
  v_mov_b32_dpp v28, v96 quad_perm:[0,0,0,0] row_mask:0xf bank_mask:0xf
  v_mov_b32_dpp v29, v100 quad_perm:[0,0,0,0] row_mask:0xf bank_mask:0xf
  v_mov_b32_dpp v30, v104 quad_perm:[0,0,0,0] row_mask:0xf bank_mask:0xf
  v_mov_b32_dpp v31, v108 quad_perm:[0,0,0,0] row_mask:0xf bank_mask:0xf
  v_add_f32_dpp v28, v97, v28 quad_perm:[1,1,1,1] row_mask:0xf bank_mask:0xf
  v_add_f32_dpp v29, v101, v29 quad_perm:[1,1,1,1] row_mask:0xf bank_mask:0xf
  v_add_f32_dpp v30, v105, v30 quad_perm:[1,1,1,1] row_mask:0xf bank_mask:0xf
  v_add_f32_dpp v31, v109, v31 quad_perm:[1,1,1,1] row_mask:0xf bank_mask:0xf
  v_add_f32_dpp v28, v98, v28 quad_perm:[2,2,2,2] row_mask:0xf bank_mask:0xf
  v_add_f32_dpp v29, v102, v29 quad_perm:[2,2,2,2] row_mask:0xf bank_mask:0xf
  v_add_f32_dpp v30, v106, v30 quad_perm:[2,2,2,2] row_mask:0xf bank_mask:0xf
  v_add_f32_dpp v31, v110, v31 quad_perm:[2,2,2,2] row_mask:0xf bank_mask:0xf
  v_add_f32_dpp v28, v99, v28 quad_perm:[3,3,3,3] row_mask:0xf bank_mask:0xf
  v_add_f32_dpp v29, v103, v29 quad_perm:[3,3,3,3] row_mask:0xf bank_mask:0xf
  v_add_f32_dpp v30, v107, v30 quad_perm:[3,3,3,3] row_mask:0xf bank_mask:0xf
  v_add_f32_dpp v31, v111, v31 quad_perm:[3,3,3,3] row_mask:0xf bank_mask:0xf
  v_cvt_pk_bf16_f32 v120, v24, v25
  v_cvt_pk_bf16_f32 v121, v26, v27
  v_cvt_pk_bf16_f32 v122, v28, v29
  v_cvt_pk_bf16_f32 v123, v30, v31
  v_lshlrev_b32 v24, 16, v120
  v_and_b32 v25, 0xffff0000, v120
  v_lshlrev_b32 v26, 16, v121
  v_and_b32 v27, 0xffff0000, v121
  v_lshlrev_b32 v28, 16, v122
  v_and_b32 v29, 0xffff0000, v122
  v_lshlrev_b32 v30, 16, v123
  v_and_b32 v31, 0xffff0000, v123
  v_max3_f32 v5, v24, v25, v26
  v_max3_f32 v6, v27, v28, v29
  v_max3_f32 v5, v5, v30, v31
  v_max_f32 v5, v5, v6
  v_mov_b32 v6, v5
  s_nop 1
  v_permlane16_swap_b32 v5, v6
  v_max_f32 v5, v5, v6
  v_mov_b32 v6, v5
  s_nop 1
  v_permlane32_swap_b32 v5, v6
  v_max_f32 v5, v5, v6
  v_mul_f32 v5, s63, v5
  v_max_f32 v5, v5, v52
  v_sub_f32 v54, v52, v5
  v_mov_b32 v52, v5
  v_exp_f32 v54, v54
  v_fma_f32 v24, v24, s63, -v52
  v_fma_f32 v25, v25, s63, -v52
  v_fma_f32 v26, v26, s63, -v52
  v_fma_f32 v27, v27, s63, -v52
  v_fma_f32 v28, v28, s63, -v52
  v_fma_f32 v29, v29, s63, -v52
  v_fma_f32 v30, v30, s63, -v52
  v_fma_f32 v31, v31, s63, -v52
  v_exp_f32 v24, v24
  v_exp_f32 v25, v25
  v_exp_f32 v26, v26
  v_exp_f32 v27, v27
  v_exp_f32 v28, v28
  v_exp_f32 v29, v29
  v_exp_f32 v30, v30
  v_exp_f32 v31, v31
  s_nop 0
  v_cvt_pk_bf16_f32 v120, v24, v25
  v_cvt_pk_bf16_f32 v121, v26, v27
  v_cvt_pk_bf16_f32 v122, v28, v29
  v_cvt_pk_bf16_f32 v123, v30, v31
  v_add_f32 v24, v24, v28
  v_add_f32 v25, v25, v29
  v_add_f32 v26, v26, v30
  v_add_f32 v27, v27, v31
  v_add_f32 v24, v24, v26
  v_add_f32 v25, v25, v27
  v_add_f32 v24, v24, v25
  v_fmac_f32 v24, v53, v54
  v_mov_b32 v25, v24
  s_nop 1
  v_permlane16_swap_b32 v24, v25
  v_add_f32 v24, v24, v25
  v_mov_b32 v25, v24
  s_nop 1
  v_permlane32_swap_b32 v24, v25
  v_add_f32 v24, v24, v25
  ds_write_b32 v58, v52 offset:1024
  ds_write_b32 v58, v24 offset:1088
  v_mov_b32 v25, 1
  v_mov_b32 v26, 0
  s_mov_b64 exec, 1
  ds_add_u32 v26, v25 offset:1220
  s_mov_b64 exec, -1
  v_readlane_b32 s58, v54, 0
  v_readlane_b32 s59, v54, 4
  v_cndmask_b32 v64, 0, v120, s[64:65]
  v_cndmask_b32 v65, 0, v121, s[64:65]
  v_cndmask_b32 v66, 0, v122, s[64:65]
  v_cndmask_b32 v67, 0, v123, s[64:65]
  v_cndmask_b32 v68, 0, v120, s[66:67]
  v_cndmask_b32 v69, 0, v121, s[66:67]
  v_cndmask_b32 v70, 0, v122, s[66:67]
  v_cndmask_b32 v71, 0, v123, s[66:67]
  v_cndmask_b32 v72, 0, v120, s[68:69]
  v_cndmask_b32 v73, 0, v121, s[68:69]
  v_cndmask_b32 v74, 0, v122, s[68:69]
  v_cndmask_b32 v75, 0, v123, s[68:69]
  v_cndmask_b32 v76, 0, v120, s[70:71]
  v_cndmask_b32 v77, 0, v121, s[70:71]
  v_cndmask_b32 v78, 0, v122, s[70:71]
  v_cndmask_b32 v79, 0, v123, s[70:71]
  v_cndmask_b32 v80, 0, v120, s[72:73]
  v_cndmask_b32 v81, 0, v121, s[72:73]
  v_cndmask_b32 v82, 0, v122, s[72:73]
  v_cndmask_b32 v83, 0, v123, s[72:73]
  v_cndmask_b32 v84, 0, v120, s[74:75]
  v_cndmask_b32 v85, 0, v121, s[74:75]
  v_cndmask_b32 v86, 0, v122, s[74:75]
  v_cndmask_b32 v87, 0, v123, s[74:75]
  v_cndmask_b32 v88, 0, v120, s[76:77]
  v_cndmask_b32 v89, 0, v121, s[76:77]
  v_cndmask_b32 v90, 0, v122, s[76:77]
  v_cndmask_b32 v91, 0, v123, s[76:77]
  v_cndmask_b32 v92, 0, v120, s[78:79]
  v_cndmask_b32 v93, 0, v121, s[78:79]
  v_cndmask_b32 v94, 0, v122, s[78:79]
  v_cndmask_b32 v95, 0, v123, s[78:79]
  v_mov_b32 v54, s58
  v_mov_b32 v5, s59
  s_mov_b32 vcc_lo, 0xffff0000
  s_mov_b32 vcc_hi, 0xffff0000
  v_cndmask_b32 v54, v54, v5, vcc
  v_mul_f32 v112, v112, v54
  v_mul_f32 v113, v113, v54
  v_mul_f32 v114, v114, v54
  v_mul_f32 v115, v115, v54
  v_mul_f32 v116, v116, v54
  v_mul_f32 v117, v117, v54
  v_mul_f32 v118, v118, v54
  v_mul_f32 v119, v119, v54
  s_waitcnt vmcnt(8)
  v_perm_b32 v40, v196, v192, s82
  v_perm_b32 v41, v204, v200, s82
  v_perm_b32 v42, v212, v208, s82
  v_perm_b32 v43, v220, v216, s82
  v_perm_b32 v44, v196, v192, s83
  v_perm_b32 v45, v204, v200, s83
  v_perm_b32 v46, v212, v208, s83
  v_perm_b32 v47, v220, v216, s83
  v_mfma_f32_16x16x32_bf16 v[112:115], v[64:67], v[40:43], v[112:115]
  v_perm_b32 v48, v197, v193, s82
  v_perm_b32 v49, v205, v201, s82
  v_perm_b32 v50, v213, v209, s82
  v_perm_b32 v51, v221, v217, s82
  v_mfma_f32_16x16x32_bf16 v[112:115], v[68:71], v[44:47], v[112:115]
  v_perm_b32 v40, v197, v193, s83
  v_perm_b32 v41, v205, v201, s83
  v_perm_b32 v42, v213, v209, s83
  v_perm_b32 v43, v221, v217, s83
  v_mfma_f32_16x16x32_bf16 v[112:115], v[72:75], v[48:51], v[112:115]
  v_perm_b32 v44, v198, v194, s82
  v_perm_b32 v45, v206, v202, s82
  v_perm_b32 v46, v214, v210, s82
  v_perm_b32 v47, v222, v218, s82
  v_mfma_f32_16x16x32_bf16 v[112:115], v[76:79], v[40:43], v[112:115]
  v_perm_b32 v48, v198, v194, s83
  v_perm_b32 v49, v206, v202, s83
  v_perm_b32 v50, v214, v210, s83
  v_perm_b32 v51, v222, v218, s83
  v_mfma_f32_16x16x32_bf16 v[112:115], v[80:83], v[44:47], v[112:115]
  v_perm_b32 v40, v199, v195, s82
  v_perm_b32 v41, v207, v203, s82
  v_perm_b32 v42, v215, v211, s82
  v_perm_b32 v43, v223, v219, s82
  v_mfma_f32_16x16x32_bf16 v[112:115], v[84:87], v[48:51], v[112:115]
  v_perm_b32 v44, v199, v195, s83
  v_perm_b32 v45, v207, v203, s83
  v_perm_b32 v46, v215, v211, s83
  v_perm_b32 v47, v223, v219, s83
  v_mfma_f32_16x16x32_bf16 v[112:115], v[88:91], v[40:43], v[112:115]
  s_nop 1
  v_mfma_f32_16x16x32_bf16 v[112:115], v[92:95], v[44:47], v[112:115]
  s_cmp_gt_u32 s56, 3
  s_cbranch_scc1 L_nowt
  s_cmp_eq_u32 s32, 14
  s_cbranch_scc1 L_nowt
  s_lshl_b32 s58, s3, 9
  s_lshl_b32 s59, s33, 8
  s_add_u32 s58, s58, s59
  s_mul_i32 s59, s56, 64
  s_add_u32 s58, s58, s59
  s_mul_i32 s58, s58, 896
  s_lshl_b32 s59, s34, 7
  s_add_u32 s35, s58, s59
  s_cmp_eq_u32 s32, 14
  s_cselect_b32 s35, 0x4000000, s35
  v_lshrrev_b32 v60, 3, v1
  v_mul_u32_u24 v61, 896, v60
  v_and_b32 v62, 7, v1
  v_and_b32 v60, 2, v60
  v_xor_b32 v62, v62, v60
  v_xor_b32 v63, 4, v62
  v_lshl_add_u32 v60, v62, 4, v61
  v_lshl_add_u32 v61, v63, 4, v61
  v_mov_b32 v62, 0
  s_waitcnt vmcnt(0)
  s_mov_b32 s62, 0x400000
L_wtw:
  ds_read_b32 v63, v62 offset:1224
  s_waitcnt lgkmcnt(0)
  v_readfirstlane_b32 s58, v63
  s_cmp_ge_u32 s58, 8
  s_cbranch_scc1 L_wtg
  s_sleep 1
  s_sub_u32 s62, s62, 1
  s_cbranch_scc0 L_wtw
L_wtg:
  s_mul_i32 s46, s56, 8192
  s_add_u32 m0, s46, 46080
  s_add_u32 s47, s35, 0
  buffer_load_dwordx4 v60, s[36:39], s47 offen nt lds
  s_add_u32 m0, s46, 47104
  s_add_u32 s47, s35, 7168
  buffer_load_dwordx4 v61, s[36:39], s47 offen nt lds
  s_add_u32 m0, s46, 48128
  s_add_u32 s47, s35, 14336
  buffer_load_dwordx4 v60, s[36:39], s47 offen nt lds
  s_add_u32 m0, s46, 49152
  s_add_u32 s47, s35, 21504
  buffer_load_dwordx4 v61, s[36:39], s47 offen nt lds
  s_add_u32 m0, s46, 50176
  s_add_u32 s47, s35, 28672
  buffer_load_dwordx4 v60, s[36:39], s47 offen nt lds
  s_add_u32 m0, s46, 51200
  s_add_u32 s47, s35, 35840
  buffer_load_dwordx4 v61, s[36:39], s47 offen nt lds
  s_add_u32 m0, s46, 52224
  s_add_u32 s47, s35, 43008
  buffer_load_dwordx4 v60, s[36:39], s47 offen nt lds
  s_add_u32 m0, s46, 53248
  s_add_u32 s47, s35, 50176
  buffer_load_dwordx4 v61, s[36:39], s47 offen nt lds
L_nowt:
  s_lshl_b32 s58, s56, 2
  v_add_u32 v6, s58, v7
  v_mov_b32 v62, 0
  s_mov_b32 s62, 0x400000
L_swait:
  ds_read_b32 v61, v62 offset:1220
  s_waitcnt lgkmcnt(0)
  v_readfirstlane_b32 s58, v61
  s_cmp_eq_u32 s58, 8
  s_cbranch_scc1 L_sready
  s_sleep 1
  s_sub_u32 s62, s62, 1
  s_cbranch_scc0 L_swait
L_sready:
  ds_read_b128 v[16:19], v7 offset:1024
  ds_read_b128 v[20:23], v7 offset:1040
  ds_read_b32 v59, v6 offset:1024
  ds_read_b128 v[24:27], v7 offset:1088
  ds_read_b128 v[28:31], v7 offset:1104
  s_waitcnt lgkmcnt(0)
  v_max3_f32 v124, v16, v17, v18
  v_max3_f32 v125, v19, v20, v21
  v_max3_f32 v124, v124, v22, v23
  v_max_f32 v124, v124, v125
  v_sub_f32 v16, v16, v124
  v_sub_f32 v17, v17, v124
  v_sub_f32 v18, v18, v124
  v_sub_f32 v19, v19, v124
  v_sub_f32 v20, v20, v124
  v_sub_f32 v21, v21, v124
  v_sub_f32 v22, v22, v124
  v_sub_f32 v23, v23, v124
  v_sub_f32 v59, v59, v124
  v_exp_f32 v16, v16
  v_exp_f32 v17, v17
  v_exp_f32 v18, v18
  v_exp_f32 v19, v19
  v_exp_f32 v20, v20
  v_exp_f32 v21, v21
  v_exp_f32 v22, v22
  v_exp_f32 v23, v23
  v_exp_f32 v59, v59
  v_mul_f32 v126, v24, v16
  v_fmac_f32 v126, v25, v17
  v_fmac_f32 v126, v26, v18
  v_fmac_f32 v126, v27, v19
  v_fmac_f32 v126, v28, v20
  v_fmac_f32 v126, v29, v21
  v_fmac_f32 v126, v30, v22
  v_fmac_f32 v126, v31, v23
  v_rcp_f32 v16, v126
  v_mov_b32 v125, v4
  v_mov_b32 v127, v4
  v_mul_f32 v59, v59, v16
  v_lshrrev_b32 v53, 4, v1
  v_lshlrev_b32 v60, 4, v1
  s_lshl_b32 s60, s7, 1
  s_cmp_lt_u32 s56, 4
  s_cbranch_scc1 L_a03
  s_cmp_eq_u32 s56, 4
  s_cbranch_scc1 L_a4
  s_cmp_eq_u32 s56, 7
  s_cbranch_scc1 L_a7
  s_sub_u32 s58, s56, 5
  s_and_b32 s59, s5, 1
  s_lshl_b32 s59, s59, 3
  s_add_u32 s59, s59, s6
  s_add_u32 s60, s60, s58
  s_lshl_b32 s44, s60, 14
  s_lshl_b32 s45, s59, 10
  s_add_u32 s44, s44, s45
  s_add_u32 s44, s44, 524288
  s_add_u32 s45, s44, 1048576
  s_lshl_b32 s60, s60, 8
  s_lshl_b32 s59, s59, 4
  s_add_u32 s60, s60, s59
  s_add_u32 s60, s60, 393216
  s_add_u32 s61, s60, 1048576
  s_lshl_b32 s59, s58, 4
  s_lshl_b64 exec, 1, s59
  s_cmp_eq_u32 s42, 1
  s_cselect_b32 s60, 0x4000000, s60
  s_cselect_b32 s44, 0x4000000, s44
  s_mov_b64 s[64:65], exec
  s_mov_b64 exec, -1
  s_lshl_b32 s59, s58, 10
  s_add_u32 s59, s59, 78848
  v_add_u32 v61, s59, v60
  v_mov_b32 v97, v4
  v_mov_b32 v99, v4
  s_waitcnt vmcnt(0)
  s_branch L_v3
L_a03:
  s_add_u32 s60, s60, s33
  v_and_b32 v54, 15, v1
  v_lshlrev_b32 v52, 10, v54
  v_lshl_add_u32 v52, v53, 5, v52
  v_lshlrev_b32 v54, 2, v54
  s_lshl_b32 s61, s60, 14
  s_lshl_b32 s58, s56, 8
  s_add_u32 s61, s61, s58
  s_add_u32 s61, s61, 1572864
  s_lshl_b32 s58, s56, 11
  v_add_u32 v61, s58, v60
  v_bfe_u32 v55, v1, 2, 2
  v_lshl_add_u32 v63, v53, 3, v55
  v_lshlrev_b32 v63, 7, v63
  v_bfe_u32 v16, v1, 1, 1
  s_lshl_b32 s58, s56, 1
  v_add_u32 v16, s58, v16
  v_and_b32 v55, 2, v55
  v_xor_b32 v16, v16, v55
  v_and_b32 v55, 1, v53
  v_lshlrev_b32 v55, 2, v55
  v_xor_b32 v16, v16, v55
  v_lshl_add_u32 v63, v16, 4, v63
  v_and_b32 v16, 1, v1
  v_lshl_add_u32 v63, v16, 3, v63
  v_add_u32 v63, 46080, v63
  s_lshl_b32 s58, s34, 2
  s_add_u32 s58, s58, s56
  s_lshl_b32 s58, s58, 15
  s_lshl_b32 s44, s60, 7
  s_add_u32 s44, s44, s58
  s_add_u32 s44, s44, 2097152
  v_and_b32 v55, 7, v1
  v_lshlrev_b32 v55, 12, v55
  v_lshl_add_u32 v55, v53, 5, v55
  v_bfe_u32 v16, v1, 3, 1
  v_lshl_add_u32 v55, v16, 4, v55
  v_mov_b32 v109, v4
  v_mov_b32 v111, v4
  s_lshl_b32 s45, s7, 2
  s_add_u32 s45, s45, 458752
  v_lshlrev_b32 v17, 8, v1
  s_cmp_eq_u32 s32, 14
  s_cbranch_scc0 L_v3
  s_branch L_nostat
L_a4:
  s_add_u32 s60, s60, s33
  s_lshl_b32 s61, s60, 8
  s_add_u32 s61, s61, 1441792
  v_and_b32 v54, 15, v1
  v_lshlrev_b32 v55, 4, v54
  v_lshlrev_b32 v54, 2, v54
  s_branch L_nostat
L_a7:
  s_lshl_b32 s61, s2, 12
  s_add_u32 s61, s61, 2097152
  v_and_b32 v54, 7, v1
  v_lshlrev_b32 v54, 2, v54
  v_lshlrev_b32 v55, 2, v1
  s_mul_i32 s21, s3, 896
  s_lshr_b32 s20, s2, 3
  s_lshl_b32 s20, s20, 5
  s_add_u32 s21, s21, s20
  s_and_b32 s20, s2, 7
  s_lshl_b32 s20, s20, 8
  s_add_u32 s20, s20, 458752
L_nostat:
  s_waitcnt vmcnt(0)
L_v3:
  v_mul_f32 v112, v112, v59
  v_mul_f32 v113, v113, v59
  v_mul_f32 v114, v114, v59
  v_mul_f32 v115, v115, v59
  ds_write_b128 v56, v[112:115]
  v_perm_b32 v40, v228, v224, s82
  v_perm_b32 v41, v236, v232, s82
  v_perm_b32 v42, v244, v240, s82
  v_perm_b32 v43, v252, v248, s82
  v_perm_b32 v44, v228, v224, s83
  v_perm_b32 v45, v236, v232, s83
  v_perm_b32 v46, v244, v240, s83
  v_perm_b32 v47, v252, v248, s83
  v_mfma_f32_16x16x32_bf16 v[116:119], v[64:67], v[40:43], v[116:119]
  v_perm_b32 v48, v229, v225, s82
  v_perm_b32 v49, v237, v233, s82
  v_perm_b32 v50, v245, v241, s82
  v_perm_b32 v51, v253, v249, s82
  v_mfma_f32_16x16x32_bf16 v[116:119], v[68:71], v[44:47], v[116:119]
  v_perm_b32 v40, v229, v225, s83
  v_perm_b32 v41, v237, v233, s83
  v_perm_b32 v42, v245, v241, s83
  v_perm_b32 v43, v253, v249, s83
  v_mfma_f32_16x16x32_bf16 v[116:119], v[72:75], v[48:51], v[116:119]
  v_perm_b32 v44, v230, v226, s82
  v_perm_b32 v45, v238, v234, s82
  v_perm_b32 v46, v246, v242, s82
  v_perm_b32 v47, v254, v250, s82
  v_mfma_f32_16x16x32_bf16 v[116:119], v[76:79], v[40:43], v[116:119]
  v_perm_b32 v48, v230, v226, s83
  v_perm_b32 v49, v238, v234, s83
  v_perm_b32 v50, v246, v242, s83
  v_perm_b32 v51, v254, v250, s83
  v_mfma_f32_16x16x32_bf16 v[116:119], v[80:83], v[44:47], v[116:119]
  v_perm_b32 v40, v231, v227, s82
  v_perm_b32 v41, v239, v235, s82
  v_perm_b32 v42, v247, v243, s82
  v_perm_b32 v43, v255, v251, s82
  v_mfma_f32_16x16x32_bf16 v[116:119], v[84:87], v[48:51], v[116:119]
  v_perm_b32 v44, v231, v227, s83
  v_perm_b32 v45, v239, v235, s83
  v_perm_b32 v46, v247, v243, s83
  v_perm_b32 v47, v255, v251, s83
  v_mfma_f32_16x16x32_bf16 v[116:119], v[88:91], v[40:43], v[116:119]
  s_nop 1
  v_mfma_f32_16x16x32_bf16 v[116:119], v[92:95], v[44:47], v[116:119]
  s_cmp_lt_u32 s56, 5
  s_nop 6
  v_mul_f32 v116, v116, v59
  v_mul_f32 v117, v117, v59
  v_mul_f32 v118, v118, v59
  v_mul_f32 v119, v119, v59
  ds_write_b128 v57, v[116:119]
  s_waitcnt lgkmcnt(0)
  s_barrier
  s_cbranch_scc1 L_cons
  s_cmp_eq_u32 s56, 7
  s_cbranch_scc1 L_w7
  ds_read_b128 v[64:67], v61 offset:0
  ds_read_b128 v[68:71], v61 offset:2048
  ds_read_b128 v[72:75], v61 offset:4096
  ds_read_b128 v[76:79], v61 offset:6144
  ds_read_b128 v[80:83], v61 offset:8192
  ds_read_b128 v[84:87], v61 offset:10240
  ds_read_b128 v[88:91], v61 offset:12288
  ds_read_b128 v[92:95], v61 offset:14336
  s_mov_b64 exec, s[64:65]
  buffer_store_dwordx4 v[124:127], v62, s[48:51], s61 offen
  buffer_store_dwordx4 v[124:127], v62, s[48:51], s60 offen sc1
  s_mov_b64 exec, -1
  s_waitcnt lgkmcnt(6)
  v_pk_add_f32 v[64:65], v[64:65], v[68:69]
  v_pk_add_f32 v[66:67], v[66:67], v[70:71]
  s_waitcnt lgkmcnt(4)
  v_pk_add_f32 v[72:73], v[72:73], v[76:77]
  v_pk_add_f32 v[74:75], v[74:75], v[78:79]
  v_pk_add_f32 v[64:65], v[64:65], v[72:73]
  v_pk_add_f32 v[66:67], v[66:67], v[74:75]
  s_waitcnt lgkmcnt(2)
  v_pk_add_f32 v[80:81], v[80:81], v[84:85]
  v_pk_add_f32 v[82:83], v[82:83], v[86:87]
  v_pk_add_f32 v[64:65], v[64:65], v[80:81]
  v_pk_add_f32 v[66:67], v[66:67], v[82:83]
  s_waitcnt lgkmcnt(0)
  v_pk_add_f32 v[88:89], v[88:89], v[92:93]
  v_pk_add_f32 v[90:91], v[90:91], v[94:95]
  v_pk_add_f32 v[64:65], v[64:65], v[88:89]
  v_pk_add_f32 v[66:67], v[66:67], v[90:91]
  v_cvt_pk_bf16_f32 v96, v64, v65
  v_cvt_pk_bf16_f32 v98, v66, v67
  buffer_store_dwordx4 v[96:99], v60, s[48:51], s45 offen
  buffer_store_dwordx4 v[96:99], v60, s[48:51], s44 offen sc1
  s_cmp_eq_u32 s32, 14
  s_cbranch_scc1 L_fin
  s_barrier
  s_barrier
  s_branch L_fin
L_cons:
  s_cmp_eq_u32 s32, 14
  s_cbranch_scc1 L_fin
  s_cmp_lt_u32 s56, 4
  s_cbranch_scc1 L_gath
  s_barrier
  s_mov_b64 exec, 0xffff
  s_mov_b32 s62, 65536
L_sg:
  buffer_load_dwordx4 v[160:163], v55, s[48:51], s61 offen sc1 nt
L_sg_w:
  s_waitcnt vmcnt(0)
  v_cmp_ne_u32 vcc, v161, v4
  v_cmp_ne_u32 s[58:59], v163, v4
  s_or_b64 vcc, vcc, s[58:59]
  s_cbranch_scc0 L_sg_ok
  s_mov_b64 exec, vcc
  s_cmp_le_u32 s62, 65280
  s_cselect_b32 s58, 1048576, 0
  s_xor_b32 s61, s61, s58
  s_sub_u32 s62, s62, 1
  s_cbranch_scc0 L_sg
L_sg_ok:
  s_mov_b64 exec, -1
  v_mov_b32_dpp v100, v160 row_ror:8 row_mask:0xf bank_mask:0xf
  v_mov_b32_dpp v101, v162 row_ror:8 row_mask:0xf bank_mask:0xf
  v_max_f32 v102, v160, v100
  v_sub_f32 v103, v160, v102
  v_sub_f32 v100, v100, v102
  v_exp_f32 v103, v103
  v_exp_f32 v100, v100
  s_nop 0
  v_mul_f32 v103, v103, v162
  v_fma_f32 v100, v100, v101, v103
  v_rcp_f32 v100, v100
  s_nop 0
  v_mul_f32 v103, v103, v100
  s_mov_b64 exec, 0xffff
  ds_write_b32 v54, v103 offset:1152
  s_waitcnt lgkmcnt(0)
  s_barrier
  s_branch L_fin
L_gath:
  s_waitcnt vmcnt(1)
  s_mov_b32 s62, 65536
  buffer_load_dwordx4 v[128:131], v52, s[48:51], s61 offen offset:0 sc1 nt
  buffer_load_dwordx4 v[132:135], v52, s[48:51], s61 offen offset:16 sc1 nt
  buffer_load_dwordx4 v[136:139], v52, s[48:51], s61 offen offset:128 sc1 nt
  buffer_load_dwordx4 v[140:143], v52, s[48:51], s61 offen offset:144 sc1 nt
  s_waitcnt vmcnt(4)
  s_barrier
  ds_read_b64_tr_b16 v[64:65], v63 offset:0
  ds_read_b64_tr_b16 v[66:67], v63 offset:512
  ds_read_b64_tr_b16 v[68:69], v63 offset:4096
  ds_read_b64_tr_b16 v[70:71], v63 offset:4608
  ds_read_b64_tr_b16 v[72:73], v63 offset:8192
  ds_read_b64_tr_b16 v[74:75], v63 offset:8704
  ds_read_b64_tr_b16 v[76:77], v63 offset:12288
  ds_read_b64_tr_b16 v[78:79], v63 offset:12800
  ds_read_b64_tr_b16 v[80:81], v63 offset:16384
  ds_read_b64_tr_b16 v[82:83], v63 offset:16896
  ds_read_b64_tr_b16 v[84:85], v63 offset:20480
  ds_read_b64_tr_b16 v[86:87], v63 offset:20992
  ds_read_b64_tr_b16 v[88:89], v63 offset:24576
  ds_read_b64_tr_b16 v[90:91], v63 offset:25088
  s_waitcnt lgkmcnt(4)
  ds_read_b64_tr_b16 v[92:93], v63 offset:28672
  ds_read_b64_tr_b16 v[94:95], v63 offset:29184
  s_branch L_g1_w
L_g1:
  buffer_load_dwordx4 v[128:131], v52, s[48:51], s61 offen offset:0 sc1 nt
  buffer_load_dwordx4 v[132:135], v52, s[48:51], s61 offen offset:16 sc1 nt
  buffer_load_dwordx4 v[136:139], v52, s[48:51], s61 offen offset:128 sc1 nt
  buffer_load_dwordx4 v[140:143], v52, s[48:51], s61 offen offset:144 sc1 nt
L_g1_w:
  s_waitcnt vmcnt(0)
  v_min3_u32 v58, v129, v131, v133
  v_max3_u32 v59, v129, v131, v133
  v_min3_u32 v58, v58, v135, v137
  v_max3_u32 v59, v59, v135, v137
  v_min3_u32 v58, v58, v139, v141
  v_max3_u32 v59, v59, v139, v141
  v_min_u32 v58, v58, v143
  v_max_u32 v59, v59, v143
  v_cmp_ne_u32 vcc, v58, v4
  v_cmp_ne_u32 s[58:59], v59, v4
  s_or_b64 vcc, vcc, s[58:59]
  s_cbranch_scc0 L_g1_ok
  s_mov_b64 exec, vcc
  s_cmp_le_u32 s62, 65280
  s_cselect_b32 s58, 1048576, 0
  s_xor_b32 s61, s61, s58
  s_sub_u32 s62, s62, 1
  s_cbranch_scc0 L_g1
L_g1_ok:
  s_mov_b64 exec, -1
  v_mov_b32 v129, v130
  v_mov_b32 v130, v132
  v_mov_b32 v131, v134
  ds_write_b128 v61, v[128:131] offset:2048
  v_mov_b32 v137, v138
  v_mov_b32 v138, v140
  v_mov_b32 v139, v142
  ds_write_b128 v61, v[136:139] offset:3072
  s_or_b32 s58, s56, s5
  s_cbranch_scc1 L_nohint
  s_mov_b64 exec, 0xff
  buffer_store_dword v4, v17, s[48:51], s45 offen sc1
  s_mov_b64 exec, -1
L_nohint:
  s_waitcnt lgkmcnt(0)
  s_barrier
  ds_read_b128 v[160:163], v60 offset:2048
  ds_read_b128 v[164:167], v60 offset:3072
  ds_read_b128 v[168:171], v60 offset:4096
  ds_read_b128 v[172:175], v60 offset:5120
  ds_read_b128 v[176:179], v60 offset:6144
  ds_read_b128 v[180:183], v60 offset:7168
  ds_read_b128 v[184:187], v60 offset:8192
  ds_read_b128 v[188:191], v60 offset:9216
  ds_read_b32 v103, v54 offset:1152
  s_waitcnt lgkmcnt(8)
  v_mfma_f32_16x16x32_bf16 v[96:99], v[64:67], v[160:163], 0
  s_waitcnt lgkmcnt(7)
  v_mfma_f32_16x16x32_bf16 v[96:99], v[68:71], v[164:167], v[96:99]
  s_waitcnt lgkmcnt(6)
  v_mfma_f32_16x16x32_bf16 v[96:99], v[72:75], v[168:171], v[96:99]
  s_waitcnt lgkmcnt(5)
  v_mfma_f32_16x16x32_bf16 v[96:99], v[76:79], v[172:175], v[96:99]
  s_waitcnt lgkmcnt(4)
  v_mfma_f32_16x16x32_bf16 v[96:99], v[80:83], v[176:179], v[96:99]
  s_waitcnt lgkmcnt(3)
  v_mfma_f32_16x16x32_bf16 v[96:99], v[84:87], v[180:183], v[96:99]
  s_waitcnt lgkmcnt(2)
  v_mfma_f32_16x16x32_bf16 v[96:99], v[88:91], v[184:187], v[96:99]
  s_waitcnt lgkmcnt(1)
  v_mfma_f32_16x16x32_bf16 v[96:99], v[92:95], v[188:191], v[96:99]
  s_waitcnt lgkmcnt(0)
  s_nop 6
  v_mul_f32 v96, v96, v103
  v_mul_f32 v97, v97, v103
  v_mul_f32 v98, v98, v103
  v_mul_f32 v99, v99, v103
  v_add_f32_dpp v104, v96, v96 row_ror:8 row_mask:0xf bank_mask:0xf
  v_add_f32_dpp v105, v97, v97 row_ror:8 row_mask:0xf bank_mask:0xf
  v_add_f32_dpp v106, v98, v98 row_ror:8 row_mask:0xf bank_mask:0xf
  v_add_f32_dpp v107, v99, v99 row_ror:8 row_mask:0xf bank_mask:0xf
  v_cndmask_b32 v108, v104, v106, s[80:81]
  v_cndmask_b32 v110, v105, v107, s[80:81]
  buffer_store_dwordx4 v[108:111], v55, s[48:51], s44 offen sc1
  s_branch L_fin
L_w7:
  s_mov_b64 s[64:65], -1
  s_mov_b64 s[66:67], -1
  s_mov_b64 s[68:69], -1
  s_mov_b64 s[70:71], -1
  s_mov_b32 s62, 65536
  s_cmp_eq_u32 s32, 14
  s_cbranch_scc1 L_nob5
  s_barrier
  s_barrier
L_nob5:
  s_cmp_ge_u32 s2, 224
  s_cbranch_scc1 L_fin
  s_mov_b64 exec, 0xffff
  buffer_load_dword v64, v55, s[48:51], s20 offen sc1
L_hp:
  s_waitcnt vmcnt(0)
  v_cmp_ne_u32 vcc, v64, v4
  s_cbranch_vccz L_hp_ok
  buffer_load_dword v64, v55, s[48:51], s20 offen sc1
  s_sub_u32 s62, s62, 1
  s_cbranch_scc0 L_hp
L_hp_ok:
L_g2:
  s_mov_b64 exec, s[64:65]
  buffer_load_dwordx4 v[128:131], v60, s[48:51], s61 offen offset:0 sc1
  s_mov_b64 exec, s[66:67]
  buffer_load_dwordx4 v[132:135], v60, s[48:51], s61 offen offset:1024 sc1
  s_mov_b64 exec, s[68:69]
  buffer_load_dwordx4 v[136:139], v60, s[48:51], s61 offen offset:2048 sc1
  s_mov_b64 exec, s[70:71]
  buffer_load_dwordx4 v[140:143], v60, s[48:51], s61 offen offset:3072 sc1
  s_mov_b64 exec, -1
  s_waitcnt vmcnt(0)
  v_cmp_ne_u32 vcc, v129, v4
  v_cmp_ne_u32 s[64:65], v131, v4
  s_or_b64 s[64:65], s[64:65], vcc
  v_cmp_ne_u32 vcc, v133, v4
  v_cmp_ne_u32 s[66:67], v135, v4
  s_or_b64 s[66:67], s[66:67], vcc
  v_cmp_ne_u32 vcc, v137, v4
  v_cmp_ne_u32 s[68:69], v139, v4
  s_or_b64 s[68:69], s[68:69], vcc
  v_cmp_ne_u32 vcc, v141, v4
  v_cmp_ne_u32 s[70:71], v143, v4
  s_or_b64 s[70:71], s[70:71], vcc
  s_or_b64 s[58:59], s[64:65], s[66:67]
  s_or_b64 vcc, s[68:69], s[70:71]
  s_or_b64 vcc, vcc, s[58:59]
  s_cbranch_scc0 L_g2_ok
  s_sub_u32 s62, s62, 1
  s_cbranch_scc0 L_g2
L_g2_ok:
  v_add_f32 v128, v128, v132
  v_add_f32 v130, v130, v134
  v_add_f32 v136, v136, v140
  v_add_f32 v138, v138, v142
  v_add_f32_dpp v128, v128, v128 row_ror:8 row_mask:0xf bank_mask:0xf
  v_add_f32_dpp v130, v130, v130 row_ror:8 row_mask:0xf bank_mask:0xf
  v_add_f32_dpp v136, v136, v136 row_ror:8 row_mask:0xf bank_mask:0xf
  v_add_f32_dpp v138, v138, v138 row_ror:8 row_mask:0xf bank_mask:0xf
  v_mov_b32 v129, v128
  v_mov_b32 v131, v130
  v_mov_b32 v137, v136
  v_mov_b32 v139, v138
  v_permlane16_swap_b32 v128, v129
  v_permlane16_swap_b32 v130, v131
  v_permlane16_swap_b32 v136, v137
  v_permlane16_swap_b32 v138, v139
  v_add_f32 v128, v128, v129
  v_add_f32 v130, v130, v131
  v_add_f32 v136, v136, v137
  v_add_f32 v138, v138, v139
  v_mov_b32 v129, v128
  v_mov_b32 v131, v130
  v_mov_b32 v137, v136
  v_mov_b32 v139, v138
  v_permlane32_swap_b32 v128, v129
  v_permlane32_swap_b32 v130, v131
  v_permlane32_swap_b32 v136, v137
  v_permlane32_swap_b32 v138, v139
  v_add_f32 v128, v128, v129
  v_add_f32 v130, v130, v131
  v_add_f32 v136, v136, v137
  v_add_f32 v138, v138, v139
  v_cvt_pk_bf16_f32 v129, v128, v130
  v_cvt_pk_bf16_f32 v137, v136, v138
  v_lshlrev_b32 v128, 16, v129
  v_and_b32 v130, 0xffff0000, v129
  v_lshlrev_b32 v136, 16, v137
  v_and_b32 v138, 0xffff0000, v137
  v_mul_f32 v128, s22, v128
  v_mul_f32 v130, s22, v130
  v_mul_f32 v136, s23, v136
  v_mul_f32 v138, s23, v138
  v_cvt_pk_bf16_f32 v129, v128, v130
  v_cvt_pk_bf16_f32 v137, v136, v138
  v_lshlrev_b32 v128, 16, v129
  v_and_b32 v130, 0xffff0000, v129
  v_lshlrev_b32 v136, 16, v137
  v_and_b32 v138, 0xffff0000, v137
  v_add_f32 v128, v128, v136
  v_add_f32 v130, v130, v138
  v_cvt_pk_bf16_f32 v128, v128, v130
  s_mov_b64 exec, 0xff
  buffer_store_dword v128, v54, s[52:55], s21 offen
  s_cmp_lg_u32 s2, 0
  s_cbranch_scc1 L_fin
  s_mov_b64 exec, 1
  buffer_store_dword v4, v54, s[48:51], 0 offen sc1
L_fin:
L_end:
  s_endpgm
L_w0b:
  s_lshl_b32 s7, s4, 3
  s_add_u32 s7, s7, s3
  v_lshlrev_b32 v33, 4, v1
  s_mov_b32 s50, 8388608
  s_mov_b32 s51, 0x20000
  s_mov_b32 s42, 7168
  s_mov_b32 s43, 0x20000
  s_mov_b32 s24, s8
  s_mov_b32 s25, s9
  v_bfe_u32 v41, v1, 2, 2
  v_lshl_add_u32 v41, v6, 3, v41
  v_lshlrev_b32 v41, 6, v41
  v_lshl_add_u32 v41, v5, 3, v41
  v_and_b32 v43, 7, v1
  v_mul_u32_u24 v42, 896, v43
  v_lshl_add_u32 v42, v6, 4, v42
  v_add_u32 v42, 38912, v42
  s_lshl_b32 s58, s7, 14
  s_lshl_b32 s59, s5, 7
  s_add_u32 s58, s58, s59
  s_add_u32 s58, s58, 65536
  s_add_u32 s59, s58, 1048576
  v_lshlrev_b32 v43, 11, v43
  v_lshl_add_u32 v43, v6, 4, v43
  s_lshl_b32 s61, s7, 3
  s_add_u32 s61, s61, s6
  s_lshl_b32 s61, s61, 11
  s_add_u32 s61, s61, 1114112
  s_waitcnt vmcnt(0)
  v_and_b32 v4, -8, v4
  v_add_u32 v4, 8, v4
  s_getreg_b32 s44, hwreg(HW_REG_XCC_ID, 0, 3)
  ds_read_b64_tr_b16 v[64:65], v41 offset:10240
  ds_read_b64_tr_b16 v[66:67], v41 offset:10496
  ds_read_b64_tr_b16 v[68:69], v41 offset:10272
  ds_read_b64_tr_b16 v[70:71], v41 offset:10528
  ds_read_b128 v[72:75], v42 offset:0
  ds_read_b64_tr_b16 v[76:77], v41 offset:12288
  ds_read_b64_tr_b16 v[78:79], v41 offset:12544
  ds_read_b64_tr_b16 v[80:81], v41 offset:12320
  ds_read_b64_tr_b16 v[82:83], v41 offset:12576
  ds_read_b128 v[84:87], v42 offset:64
  ds_read_b64_tr_b16 v[88:89], v41 offset:14336
  ds_read_b64_tr_b16 v[90:91], v41 offset:14592
  ds_read_b64_tr_b16 v[92:93], v41 offset:14368
  ds_read_b64_tr_b16 v[94:95], v41 offset:14624
  ds_read_b128 v[96:99], v42 offset:128
  s_waitcnt lgkmcnt(0)
  v_mfma_f32_16x16x32_bf16 v[44:47], v[64:67], v[72:75], 0
  v_mfma_f32_16x16x32_bf16 v[48:51], v[68:71], v[72:75], 0
  v_mfma_f32_16x16x32_bf16 v[44:47], v[76:79], v[84:87], v[44:47]
  v_mfma_f32_16x16x32_bf16 v[48:51], v[80:83], v[84:87], v[48:51]
  v_mfma_f32_16x16x32_bf16 v[44:47], v[88:91], v[96:99], v[44:47]
  v_mfma_f32_16x16x32_bf16 v[48:51], v[92:95], v[96:99], v[48:51]
  ds_read_b64_tr_b16 v[64:65], v41 offset:16384
  ds_read_b64_tr_b16 v[66:67], v41 offset:16640
  ds_read_b64_tr_b16 v[68:69], v41 offset:16416
  ds_read_b64_tr_b16 v[70:71], v41 offset:16672
  ds_read_b128 v[72:75], v42 offset:192
  ds_read_b64_tr_b16 v[76:77], v41 offset:18432
  ds_read_b64_tr_b16 v[78:79], v41 offset:18688
  ds_read_b64_tr_b16 v[80:81], v41 offset:18464
  ds_read_b64_tr_b16 v[82:83], v41 offset:18720
  ds_read_b128 v[84:87], v42 offset:256
  ds_read_b64_tr_b16 v[88:89], v41 offset:20480
  ds_read_b64_tr_b16 v[90:91], v41 offset:20736
  ds_read_b64_tr_b16 v[92:93], v41 offset:20512
  ds_read_b64_tr_b16 v[94:95], v41 offset:20768
  ds_read_b128 v[96:99], v42 offset:320
  s_waitcnt lgkmcnt(0)
  v_mfma_f32_16x16x32_bf16 v[44:47], v[64:67], v[72:75], v[44:47]
  v_mfma_f32_16x16x32_bf16 v[48:51], v[68:71], v[72:75], v[48:51]
  v_mfma_f32_16x16x32_bf16 v[44:47], v[76:79], v[84:87], v[44:47]
  v_mfma_f32_16x16x32_bf16 v[48:51], v[80:83], v[84:87], v[48:51]
  v_mfma_f32_16x16x32_bf16 v[44:47], v[88:91], v[96:99], v[44:47]
  v_mfma_f32_16x16x32_bf16 v[48:51], v[92:95], v[96:99], v[48:51]
  ds_read_b64_tr_b16 v[64:65], v41 offset:22528
  ds_read_b64_tr_b16 v[66:67], v41 offset:22784
  ds_read_b64_tr_b16 v[68:69], v41 offset:22560
  ds_read_b64_tr_b16 v[70:71], v41 offset:22816
  ds_read_b128 v[72:75], v42 offset:384
  ds_read_b64_tr_b16 v[76:77], v41 offset:24576
  ds_read_b64_tr_b16 v[78:79], v41 offset:24832
  ds_read_b64_tr_b16 v[80:81], v41 offset:24608
  ds_read_b64_tr_b16 v[82:83], v41 offset:24864
  ds_read_b128 v[84:87], v42 offset:448
  ds_read_b64_tr_b16 v[88:89], v41 offset:26624
  ds_read_b64_tr_b16 v[90:91], v41 offset:26880
  ds_read_b64_tr_b16 v[92:93], v41 offset:26656
  ds_read_b64_tr_b16 v[94:95], v41 offset:26912
  ds_read_b128 v[96:99], v42 offset:512
  s_waitcnt lgkmcnt(0)
  v_mfma_f32_16x16x32_bf16 v[44:47], v[64:67], v[72:75], v[44:47]
  v_mfma_f32_16x16x32_bf16 v[48:51], v[68:71], v[72:75], v[48:51]
  v_mfma_f32_16x16x32_bf16 v[44:47], v[76:79], v[84:87], v[44:47]
  v_mfma_f32_16x16x32_bf16 v[48:51], v[80:83], v[84:87], v[48:51]
  v_mfma_f32_16x16x32_bf16 v[44:47], v[88:91], v[96:99], v[44:47]
  v_mfma_f32_16x16x32_bf16 v[48:51], v[92:95], v[96:99], v[48:51]
  ds_read_b64_tr_b16 v[64:65], v41 offset:28672
  ds_read_b64_tr_b16 v[66:67], v41 offset:28928
  ds_read_b64_tr_b16 v[68:69], v41 offset:28704
  ds_read_b64_tr_b16 v[70:71], v41 offset:28960
  ds_read_b128 v[72:75], v42 offset:576
  ds_read_b64_tr_b16 v[76:77], v41 offset:30720
  ds_read_b64_tr_b16 v[78:79], v41 offset:30976
  ds_read_b64_tr_b16 v[80:81], v41 offset:30752
  ds_read_b64_tr_b16 v[82:83], v41 offset:31008
  ds_read_b128 v[84:87], v42 offset:640
  ds_read_b64_tr_b16 v[88:89], v41 offset:32768
  ds_read_b64_tr_b16 v[90:91], v41 offset:33024
  ds_read_b64_tr_b16 v[92:93], v41 offset:32800
  ds_read_b64_tr_b16 v[94:95], v41 offset:33056
  ds_read_b128 v[96:99], v42 offset:704
  s_waitcnt lgkmcnt(0)
  v_mfma_f32_16x16x32_bf16 v[44:47], v[64:67], v[72:75], v[44:47]
  v_mfma_f32_16x16x32_bf16 v[48:51], v[68:71], v[72:75], v[48:51]
  v_mfma_f32_16x16x32_bf16 v[44:47], v[76:79], v[84:87], v[44:47]
  v_mfma_f32_16x16x32_bf16 v[48:51], v[80:83], v[84:87], v[48:51]
  v_mfma_f32_16x16x32_bf16 v[44:47], v[88:91], v[96:99], v[44:47]
  v_mfma_f32_16x16x32_bf16 v[48:51], v[92:95], v[96:99], v[48:51]
  ds_read_b64_tr_b16 v[64:65], v41 offset:34816
  ds_read_b64_tr_b16 v[66:67], v41 offset:35072
  ds_read_b64_tr_b16 v[68:69], v41 offset:34848
  ds_read_b64_tr_b16 v[70:71], v41 offset:35104
  ds_read_b128 v[72:75], v42 offset:768
  ds_read_b64_tr_b16 v[76:77], v41 offset:36864
  ds_read_b64_tr_b16 v[78:79], v41 offset:37120
  ds_read_b64_tr_b16 v[80:81], v41 offset:36896
  ds_read_b64_tr_b16 v[82:83], v41 offset:37152
  ds_read_b128 v[84:87], v42 offset:832
  s_waitcnt lgkmcnt(0)
  v_mfma_f32_16x16x32_bf16 v[44:47], v[64:67], v[72:75], v[44:47]
  v_mfma_f32_16x16x32_bf16 v[48:51], v[68:71], v[72:75], v[48:51]
  v_mfma_f32_16x16x32_bf16 v[44:47], v[76:79], v[84:87], v[44:47]
  v_mfma_f32_16x16x32_bf16 v[48:51], v[80:83], v[84:87], v[48:51]
  v_or_b32 v53, s44, v4
  v_mov_b32 v55, v53
  v_and_b32 v40, 8, v1
  v_lshl_add_u32 v43, v40, 3, v43
  s_mov_b32 vcc_lo, 0xff00ff00
  s_mov_b32 vcc_hi, 0xff00ff00
  s_mov_b32 s45, s58
  s_nop 0
  v_cndmask_b32 v44, v44, v48, vcc
  v_cndmask_b32 v45, v45, v49, vcc
  v_cndmask_b32 v46, v46, v50, vcc
  v_cndmask_b32 v47, v47, v51, vcc
  v_cvt_pk_bf16_f32 v52, v44, v45
  v_cvt_pk_bf16_f32 v54, v46, v47
  buffer_store_dwordx4 v[52:55], v43, s[48:51], s59 offen
  s_xor_b32 s47, s57, 0
  buffer_load_dwordx4 v[128:131], v2, s[24:27], s47 offen nt
  s_xor_b32 s47, s57, 256
  buffer_load_dwordx4 v[132:135], v2, s[24:27], s47 offen nt
  s_xor_b32 s47, s57, 512
  buffer_load_dwordx4 v[136:139], v2, s[24:27], s47 offen nt
  s_xor_b32 s47, s57, 768
  buffer_load_dwordx4 v[140:143], v2, s[24:27], s47 offen nt
  s_xor_b32 s47, s57, 1024
  buffer_load_dwordx4 v[144:147], v2, s[24:27], s47 offen nt
  s_xor_b32 s47, s57, 1280
  buffer_load_dwordx4 v[148:151], v2, s[24:27], s47 offen nt
  s_xor_b32 s47, s57, 1536
  buffer_load_dwordx4 v[152:155], v2, s[24:27], s47 offen nt
  s_xor_b32 s47, s57, 1792
  buffer_load_dwordx4 v[156:159], v2, s[24:27], s47 offen nt
  s_xor_b32 s47, s57, 2048
  buffer_load_dwordx4 v[160:163], v2, s[24:27], s47 offen nt
  s_xor_b32 s47, s57, 2304
  buffer_load_dwordx4 v[164:167], v2, s[24:27], s47 offen nt
  s_xor_b32 s47, s57, 2560
  buffer_load_dwordx4 v[168:171], v2, s[24:27], s47 offen nt
  s_xor_b32 s47, s57, 2816
  buffer_load_dwordx4 v[172:175], v2, s[24:27], s47 offen nt
  s_xor_b32 s47, s57, 3072
  buffer_load_dwordx4 v[176:179], v2, s[24:27], s47 offen nt
  s_xor_b32 s47, s57, 3328
  buffer_load_dwordx4 v[180:183], v2, s[24:27], s47 offen nt
  s_xor_b32 s47, s57, 3584
  buffer_load_dwordx4 v[184:187], v2, s[24:27], s47 offen nt
  s_xor_b32 s47, s57, 3840
  buffer_load_dwordx4 v[188:191], v2, s[24:27], s47 offen nt
  s_xor_b32 s47, s57, 131072
  buffer_load_dwordx4 v[192:195], v2, s[24:27], s47 offen nt
  s_xor_b32 s47, s57, 131328
  buffer_load_dwordx4 v[196:199], v2, s[24:27], s47 offen nt
  s_xor_b32 s47, s57, 131584
  buffer_load_dwordx4 v[200:203], v2, s[24:27], s47 offen nt
  s_xor_b32 s47, s57, 131840
  buffer_load_dwordx4 v[204:207], v2, s[24:27], s47 offen nt
  s_xor_b32 s47, s57, 132096
  buffer_load_dwordx4 v[208:211], v2, s[24:27], s47 offen nt
  s_xor_b32 s47, s57, 132352
  buffer_load_dwordx4 v[212:215], v2, s[24:27], s47 offen nt
  s_xor_b32 s47, s57, 132608
  buffer_load_dwordx4 v[216:219], v2, s[24:27], s47 offen nt
  s_xor_b32 s47, s57, 132864
  buffer_load_dwordx4 v[220:223], v2, s[24:27], s47 offen nt
  s_xor_b32 s47, s57, 133120
  buffer_load_dwordx4 v[224:227], v2, s[24:27], s47 offen nt
  s_xor_b32 s47, s57, 133376
  buffer_load_dwordx4 v[228:231], v2, s[24:27], s47 offen nt
  s_xor_b32 s47, s57, 133632
  buffer_load_dwordx4 v[232:235], v2, s[24:27], s47 offen nt
  s_xor_b32 s47, s57, 133888
  buffer_load_dwordx4 v[236:239], v2, s[24:27], s47 offen nt
  s_xor_b32 s47, s57, 134144
  buffer_load_dwordx4 v[240:243], v2, s[24:27], s47 offen nt
  s_xor_b32 s47, s57, 134400
  buffer_load_dwordx4 v[244:247], v2, s[24:27], s47 offen nt
  s_xor_b32 s47, s57, 134656
  buffer_load_dwordx4 v[248:251], v2, s[24:27], s47 offen nt
  s_xor_b32 s47, s57, 134912
  buffer_load_dwordx4 v[252:255], v2, s[24:27], s47 offen nt
  s_mov_b32 s46, 1
  s_mov_b32 s62, 65536
L_qg:
  buffer_load_dwordx4 v[64:67], v33, s[48:51], s61 offen sc1 nt
  buffer_load_dwordx4 v[68:71], v33, s[48:51], s61 offen offset:1024 sc1 nt
  s_waitcnt vmcnt(0)
  v_xor_b32 v76, v65, v4
  v_xor_b32 v78, v67, v4
  v_xor_b32 v80, v69, v4
  v_xor_b32 v82, v71, v4
  v_max3_u32 v60, v76, v78, v80
  v_max_u32 v60, v60, v82
  v_cmp_lt_u32 vcc, 7, v60
  s_cbranch_vccz L_qg_ok
  s_mov_b64 exec, vcc
  s_cmp_le_u32 s62, 65280
  s_cselect_b32 s58, 1048576, 0
  s_xor_b32 s61, s61, s58
  s_cmp_lg_u32 s62, 65280
  s_cbranch_scc1 L_qg_n
  s_mov_b64 exec, -1
  buffer_store_dwordx4 v[52:55], v43, s[48:51], s45 offen sc1
  s_mov_b64 exec, vcc
L_qg_n:
  s_sub_u32 s62, s62, 1
  s_cbranch_scc0 L_qg
L_qg_ok:
  s_mov_b64 exec, -1
  v_min3_u32 v60, v65, v67, v69
  v_max3_u32 v61, v65, v67, v69
  v_min_u32 v60, v60, v71
  v_max_u32 v61, v61, v71
  v_cmp_ne_u32 vcc, v60, v53
  v_cmp_ne_u32 s[58:59], v61, v53
  s_or_b64 vcc, vcc, s[58:59]
  s_cbranch_scc0 L_qg_loc
  buffer_store_dwordx4 v[52:55], v43, s[48:51], s45 offen sc1
  s_mov_b32 s46, 2
L_qg_loc:
  v_lshlrev_b32 v60, 3, v1
  ds_write2_b32 v60, v64, v66 offset0:0 offset1:1
  ds_write2_b32 v60, v68, v70 offset0:128 offset1:129
  v_or_b32 v61, s46, v4
  ds_write_b32 v34, v61 offset:1216
  s_branch L_kq0
L_codeend:
.section .rodata,"a"
.p2align 6
.amdhsa_kernel gated_mix__sliding_block_cached__sliding_block_cached__decode_kernel
  .amdhsa_next_free_vgpr 256
  .amdhsa_next_free_sgpr 102
  .amdhsa_accum_offset 256
  .amdhsa_group_segment_fixed_size 0
  .amdhsa_kernarg_size 112
  .amdhsa_user_sgpr_count 2
  .amdhsa_user_sgpr_kernarg_segment_ptr 1
  .amdhsa_system_sgpr_workgroup_id_x 1
  .amdhsa_float_denorm_mode_32 3
.end_amdhsa_kernel
```
